```python
import torch

def _softmax(x, axis=-1):
    return torch.softmax(x, dim=axis)
def _gelu(x):
    return torch.nn.functional.gelu(x, approximate="tanh")
def _silu(x):
    return torch.nn.functional.silu(x)
def _sigmoid(x):
    return torch.sigmoid(x)
def _layernorm(x, axis=-1, eps=1e-5):
    m = x.mean(dim=axis, keepdim=True)
    v = x.var(dim=axis, keepdim=True, unbiased=False)
    return (x - m) / torch.sqrt(v + eps)
def _scatter_add(tgt, idx, src, axis=0):
    return tgt.clone().index_add_(axis, idx, src)
def _segment_sum(src, seg, n):
    out = torch.zeros((n,) + src.shape[1:], dtype=src.dtype)
    return out.index_add_(0, seg, src)
def _pad(x, pw):
    flat = tuple(v for pair in reversed(pw) for v in pair)
    return torch.nn.functional.pad(x, flat)

kernel_name = 'sequential_preLN__compressed_kv_cla__glu_gated_reglu__decode'

def setup_inputs():

    _w = (lambda a: (lambda t: t.to(torch.bfloat16) if t.is_floating_point() else t)(torch.as_tensor(a)))
    def _A_setup():
        B, H, Sq, Sk, D, M = 4, 32, 1, 4096, 128, 512
        Dc = 4 * D
        return {
            "x": _w((lambda *s: torch.randn(*s, dtype=torch.bfloat16) * 0.05)(B, Sq, M)),
            "c_kv": _w((lambda *s: torch.randn(*s, dtype=torch.bfloat16) * 0.8)(B, Sk, Dc)),
            "w_q": _w((lambda *s: torch.randn(*s, dtype=torch.bfloat16) * 1.6)(M, H, D) * (M ** -0.5)),
            "w_uk": _w((lambda *s: torch.randn(*s, dtype=torch.bfloat16) * 1.6)(Dc, H, D) * (Dc ** -0.5)),
            "w_uv": _w((lambda *s: torch.randn(*s, dtype=torch.bfloat16) * 0.8)(Dc, H, D) * (Dc ** -0.5)),
            "w_o": _w((lambda *s: torch.randn(*s, dtype=torch.bfloat16) * 0.8)(H, D, M) * ((H * D) ** -0.5)),
        }
    _A_in = _A_setup()

    def _B_setup():
        B, S, D, F = 4, 1, 512, 1792
        return {
            "x": _w((lambda *s: torch.randn(*s, dtype=torch.bfloat16) * 0.05)(B, S, D)),
            "W_gate": _w((lambda *s: torch.randn(*s, dtype=torch.bfloat16) * 0.4)(D, F) * (2.0 / D) ** 0.5),
            "W_up": _w((lambda *s: torch.randn(*s, dtype=torch.bfloat16) * 0.4)(D, F) * (2.0 / D) ** 0.5),
            "W_down": _w((lambda *s: torch.randn(*s, dtype=torch.bfloat16) * 0.4)(F, D) * (1.0 / F) ** 0.5),
        }
    _B_in = _B_setup()

    return {
        "A_x": _A_in["x"],
        "A_c_kv": _A_in["c_kv"],
        "A_w_q": _A_in["w_q"],
        "A_w_uk": _A_in["w_uk"],
        "A_w_uv": _A_in["w_uv"],
        "A_w_o": _A_in["w_o"],
        "B_x": _B_in["x"],
        "B_W_gate": _B_in["W_gate"],
        "B_W_up": _B_in["W_up"],
        "B_W_down": _B_in["W_down"],
    }

def reference(A_x, A_c_kv, A_w_q, A_w_uk, A_w_uv, A_w_o, B_x, B_W_gate, B_W_up, B_W_down):
    def _A_ref(x, c_kv, w_q, w_uk, w_uv, w_o):
        B, Sq, M = x.shape[0], x.shape[1], x.shape[2]
        Sk = c_kv.shape[1]
        H, D = w_q.shape[1], w_q.shape[2]
        q = torch.einsum("bqm,mhd->bhqd", x, w_q)
        k = torch.einsum("bkc,chd->bhkd", c_kv, w_uk)
        v = torch.einsum("bkc,chd->bhkd", c_kv, w_uv)
        scores = torch.einsum("bhqd,bhkd->bhqk", q, k) * (D ** -0.5)
        off = Sk - Sq
        qi = torch.arange(Sq)[:, None]
        kj = torch.arange(Sk)[None, :]
        cmask = kj <= (qi + off)
        scores = torch.where(cmask[None, None], scores, -1e9)
        p = _softmax(scores, axis=-1)
        ctx = torch.einsum("bhqk,bhkd->bhqd", p, v)
        return torch.einsum("bhqd,hdm->bqm", ctx, w_o)

    def _B_ref(x, W_gate, W_up, W_down):
        gate = torch.einsum("bsd,df->bsf", x, W_gate)
        up = torch.einsum("bsd,df->bsf", x, W_up)
        gate = gate * (lambda x, dt: x.to(dt))(gate > 0, gate.dtype)
        h = gate * up
        return torch.einsum("bsf,fd->bsd", h, W_down)

    x = A_x
    h = x + _A_ref(_layernorm(x, axis=-1), A_c_kv, A_w_q, A_w_uk, A_w_uv, A_w_o)
    h2 = h + _B_ref(_layernorm(h, axis=-1), B_W_gate, B_W_up, B_W_down)
    return h2
```

```asm
; @launch grid=(256,1,1) block=(512,1,1) lds=163840
.amdgcn_target "amdgcn-amd-amdhsa--gfx950"
.text
.globl sequential_preLN__compressed_kv_cla__glu_gated_reglu__decode_kernel
.p2align 8
.type sequential_preLN__compressed_kv_cla__glu_gated_reglu__decode_kernel,@function
sequential_preLN__compressed_kv_cla__glu_gated_reglu__decode_kernel:
    s_cmp_ge_u32 s2, 256
    s_cbranch_scc1 L_exit
    s_load_dwordx2 s[12:13], s[0:1], 8
    s_load_dwordx2 s[8:9], s[0:1], 0
    s_load_dwordx2 s[16:17], s[0:1], 16
    s_load_dwordx2 s[20:21], s[0:1], 24
    s_load_dwordx2 s[48:49], s[0:1], 96
    v_lshrrev_b32 v6, 6, v0
    v_and_b32 v1, 63, v0
    v_readfirstlane_b32 s3, v6
    v_lshrrev_b32 v2, 4, v1
    v_and_b32 v3, 15, v1
    v_and_b32 v4, 3, v1
    v_lshrrev_b32 v5, 2, v3
    v_lshlrev_b32 v228, 4, v1
    v_and_b32 v8, 7, v1
    v_bfe_u32 v9, v1, 3, 1
    v_mul_u32_u24 v9, 1056, v9
    v_lshl_add_u32 v8, v8, 2, v9
    v_add_u32 v8, 102400, v8
    v_mov_b32 v9, 0
    ds_write_b32 v8, v9
    v_bfe_u32 v6, v1, 2, 1
    v_lshlrev_b32 v243, 10, v4
    v_lshl_add_u32 v243, v6, 5, v243
    s_getpc_b64 s[6:7]
L_pc:
    s_bfe_u32 s61, s2, 0x10003
    s_lshl_b32 s61, s61, 13
    v_lshl_add_u32 v8, v1, 7, s61
    s_cmp_lg_u32 s3, 3
    s_cbranch_scc1 L_nocpf
    s_cmp_ge_u32 s2, 32
    s_cbranch_scc1 L_nocpf
    v_cmp_gt_u32 vcc, L_exit-L_pc, v8
    s_nop 0
    s_and_b64 exec, exec, vcc
    s_cbranch_execz L_nocpf2
    global_load_dword v201, v8, s[6:7]
L_nocpf2:
    s_mov_b64 exec, -1
L_nocpf:
    s_mov_b32 s10, 4096
    s_mov_b32 s11, 0x00020000
    s_mov_b32 s14, 16777216
    s_mov_b32 s15, 0x00020000
    s_mov_b32 s18, 4194304
    s_mov_b32 s19, 0x00020000
    s_mov_b32 s22, 4194304
    s_mov_b32 s23, 0x00020000
    s_mov_b32 s26, 4194304
    s_mov_b32 s27, 0x00020000
    s_mov_b32 s30, 4194304
    s_mov_b32 s31, 0x00020000
    s_mov_b32 s34, 1835008
    s_mov_b32 s35, 0x00020000
    s_mov_b32 s38, 1835008
    s_mov_b32 s39, 0x00020000
    s_mov_b32 s42, 1835008
    s_mov_b32 s43, 0x00020000
    s_mov_b32 s46, 4096
    s_mov_b32 s47, 0x00020000
    s_mov_b32 s50, 16777216
    s_mov_b32 s51, 0x00020000
    s_and_b32 s55, s2, 7
    s_bfe_u32 s59, s2, 0x40003
    s_and_b32 s63, s59, 3
    s_lshl2_add_u32 s52, s55, s63
    s_lshr_b32 s53, s59, 2
    s_lshl4_add_u32 s57, s55, s59
    s_lshr_b32 s54, s57, 5
    s_lshr_b32 s56, s2, 7
    s_and_b32 s58, s3, 3
    s_mov_b32 s82, 0x3f803f80
    s_mov_b32 s83, 0x00010001
    s_getreg_b32 s89, hwreg(HW_REG_XCC_ID, 0, 4)
    s_waitcnt lgkmcnt(0)
    s_load_dword s5, s[48:49], 0
    s_load_dwordx2 s[24:25], s[0:1], 32
    s_load_dwordx2 s[28:29], s[0:1], 40
    s_load_dwordx2 s[32:33], s[0:1], 56
    s_load_dwordx2 s[36:37], s[0:1], 64
    s_load_dwordx2 s[40:41], s[0:1], 72
    s_load_dwordx2 s[44:45], s[0:1], 80
    s_cmp_eq_u32 s56, 0
    s_cbranch_scc1 L_g0front
    s_cmp_lg_u32 s3, 0
    s_cbranch_scc1 L_nox
    v_lshlrev_b32 v6, 10, v2
    v_lshl_add_u32 v6, v3, 4, v6
    s_lshl_b32 s61, s53, 8
    buffer_load_dwordx4 v[16:19], v6, s[8:11], s61 offen
    s_add_u32 s61, s61, 256
    s_and_b32 s61, s61, 1023
    buffer_load_dwordx4 v[20:23], v6, s[8:11], s61 offen
    s_add_u32 s61, s61, 256
    s_and_b32 s61, s61, 1023
    buffer_load_dwordx4 v[24:27], v6, s[8:11], s61 offen
    s_add_u32 s61, s61, 256
    s_and_b32 s61, s61, 1023
    buffer_load_dwordx4 v[28:31], v6, s[8:11], s61 offen
L_nox:
    v_lshlrev_b32 v7, 1, v2
    v_xor_b32 v7, v7, v3
    v_lshlrev_b32 v7, 4, v7
    v_lshl_add_u32 v7, v2, 13, v7
    s_lshl_b32 s64, s53, 20
    s_lshl_b32 s62, s3, 17
    s_add_u32 s64, s64, s62
    s_lshl_b32 s62, s52, 8
    s_add_u32 s64, s64, s62
    s_mul_i32 s63, s3, 4608
    s_mov_b32 s61, s64
    s_add_u32 m0, s63, 0
    s_nop 0
    buffer_load_dwordx4 v7, s[16:19], s61 offen lds
    s_add_u32 s61, s61, 0x8000
    s_add_u32 m0, s63, 1152
    s_nop 0
    buffer_load_dwordx4 v7, s[16:19], s61 offen lds
    s_add_u32 s61, s61, 0x8000
    s_add_u32 m0, s63, 2304
    s_nop 0
    buffer_load_dwordx4 v7, s[16:19], s61 offen lds
    s_add_u32 s61, s61, 0x8000
    s_add_u32 m0, s63, 3456
    s_nop 0
    buffer_load_dwordx4 v7, s[16:19], s61 offen lds
    v_mul_u32_u24 v9, 1152, v2
    v_lshl_add_u32 v9, v5, 8, v9
    v_lshl_add_u32 v9, v4, 3, v9
    v_xor_b32 v8, s3, v5
    v_lshl_add_u32 v9, v8, 5, v9
    v_mul_u32_u24 v14, 272, v4
    v_lshl_add_u32 v14, v2, 3, v14
    v_add_u32 v14, 135168, v14
    v_lshlrev_b32 v11, 8, v2
    v_lshl_add_u32 v11, v4, 4, v11
    s_mul_i32 s63, s3, 4352
    s_lshl_b32 s65, s52, 13
    s_lshl_b32 s62, s3, 10
    s_add_u32 s65, s65, s62
    s_add_u32 s65, s65, 262144
    s_lshl_b32 s66, s53, 6
    s_add_u32 s66, s66, s65
    s_xor_b32 s68, s66, 786432
    v_mul_u32_u24 v8, 1088, v5
    v_lshl_add_u32 v8, v4, 8, v8
    v_and_b32 v10, 1, v2
    v_lshl_add_u32 v8, v10, 3, v8
    v_add_u32 v8, s63, v8
    v_lshrrev_b32 v10, 1, v2
    v_xor_b32 v10, v10, v4
    v_xor_b32 v124, 2, v10
    v_lshl_add_u32 v10, v10, 4, v8
    v_lshl_add_u32 v124, v124, 4, v8
    v_add_u32 v125, 156672, v228
    s_lshr_b32 s61, s3, 1
    s_lshl_b32 s61, s61, 10
    s_and_b32 s62, s3, 1
    s_lshl_b32 s87, s62, 3
    s_add_u32 s61, s61, s87
    v_add_u32 v126, s61, v125
    v_lshlrev_b32 v127, 4, v3
    v_lshl_add_u32 v127, v2, 15, v127
    s_lshl_b32 s61, s3, 5
    s_add_u32 s61, s61, 160768
    v_lshl_add_u32 v152, v4, 8, s61
    v_lshl_add_u32 v152, v2, 3, v152
    v_add_u32 v153, 160768, v228
    v_xor_b32 v7, v2, v3
    v_lshlrev_b32 v7, 4, v7
    v_lshl_add_u32 v7, v2, 13, v7
    s_lshl_b32 s67, s52, 10
    s_lshl_b32 s62, s53, 8
    s_add_u32 s67, s67, s62
    s_add_u32 s67, s67, 786432
    s_waitcnt lgkmcnt(0)
    s_add_u32 s4, s5, 0x9e3779b9
    v_mov_b32 v15, s4
    v_mov_b32 v122, s4
    v_mov_b32 v123, s4
    v_lshl_add_u32 v8, v2, 1, s87
    v_lshrrev_b32 v154, v8, v15
    v_lshrrev_b32 v155, 1, v154
    s_mov_b32 s86, 0x07060302
    s_mov_b32 s83, 0x00010001
    s_cmp_lg_u32 s3, 0
    s_cbranch_scc1 L_noln
    s_waitcnt vmcnt(4)
    v_mov_b32 v12, 0
    v_dot2c_f32_bf16 v12, s82, v16
    v_dot2c_f32_bf16 v12, s82, v17
    v_dot2c_f32_bf16 v12, s82, v18
    v_dot2c_f32_bf16 v12, s82, v19
    v_dot2c_f32_bf16 v12, s82, v20
    v_dot2c_f32_bf16 v12, s82, v21
    v_dot2c_f32_bf16 v12, s82, v22
    v_dot2c_f32_bf16 v12, s82, v23
    v_dot2c_f32_bf16 v12, s82, v24
    v_dot2c_f32_bf16 v12, s82, v25
    v_dot2c_f32_bf16 v12, s82, v26
    v_dot2c_f32_bf16 v12, s82, v27
    v_dot2c_f32_bf16 v12, s82, v28
    v_dot2c_f32_bf16 v12, s82, v29
    v_dot2c_f32_bf16 v12, s82, v30
    v_dot2c_f32_bf16 v12, s82, v31
    v_mul_u32_u24 v6, 272, v2
    v_lshl_add_u32 v6, v3, 4, v6
    v_add_u32 v6, 135168, v6
    v_add_f32_dpp v12, v12, v12 row_ror:1 row_mask:0xf bank_mask:0xf
    s_nop 1
    v_add_f32_dpp v12, v12, v12 row_ror:2 row_mask:0xf bank_mask:0xf
    s_nop 1
    v_add_f32_dpp v12, v12, v12 row_ror:4 row_mask:0xf bank_mask:0xf
    s_nop 1
    v_add_f32_dpp v12, v12, v12 row_ror:8 row_mask:0xf bank_mask:0xf
    v_mul_f32 v12, 0xbb000000, v12
    v_mov_b32 v13, v12
    v_mov_b32 v44, 0
    v_mov_b32 v45, 0
    v_lshlrev_b32 v48, 16, v16
    v_and_b32 v49, 0xffff0000, v16
    v_pk_add_f32 v[48:49], v[48:49], v[12:13]
    v_cvt_pk_bf16_f32 v40, v48, v49
    v_pk_fma_f32 v[44:45], v[48:49], v[48:49], v[44:45]
    v_lshlrev_b32 v50, 16, v17
    v_and_b32 v51, 0xffff0000, v17
    v_pk_add_f32 v[50:51], v[50:51], v[12:13]
    v_cvt_pk_bf16_f32 v41, v50, v51
    v_pk_fma_f32 v[44:45], v[50:51], v[50:51], v[44:45]
    v_lshlrev_b32 v52, 16, v18
    v_and_b32 v53, 0xffff0000, v18
    v_pk_add_f32 v[52:53], v[52:53], v[12:13]
    v_cvt_pk_bf16_f32 v42, v52, v53
    v_pk_fma_f32 v[44:45], v[52:53], v[52:53], v[44:45]
    v_lshlrev_b32 v54, 16, v19
    v_and_b32 v55, 0xffff0000, v19
    v_pk_add_f32 v[54:55], v[54:55], v[12:13]
    v_cvt_pk_bf16_f32 v43, v54, v55
    ds_write_b128 v6, v[40:43]
    v_pk_fma_f32 v[44:45], v[54:55], v[54:55], v[44:45]
    v_lshlrev_b32 v56, 16, v20
    v_and_b32 v57, 0xffff0000, v20
    v_pk_add_f32 v[56:57], v[56:57], v[12:13]
    v_pk_fma_f32 v[44:45], v[56:57], v[56:57], v[44:45]
    v_lshlrev_b32 v58, 16, v21
    v_and_b32 v59, 0xffff0000, v21
    v_pk_add_f32 v[58:59], v[58:59], v[12:13]
    v_pk_fma_f32 v[44:45], v[58:59], v[58:59], v[44:45]
    v_lshlrev_b32 v60, 16, v22
    v_and_b32 v61, 0xffff0000, v22
    v_pk_add_f32 v[60:61], v[60:61], v[12:13]
    v_pk_fma_f32 v[44:45], v[60:61], v[60:61], v[44:45]
    v_lshlrev_b32 v62, 16, v23
    v_and_b32 v63, 0xffff0000, v23
    v_pk_add_f32 v[62:63], v[62:63], v[12:13]
    v_pk_fma_f32 v[44:45], v[62:63], v[62:63], v[44:45]
    v_lshlrev_b32 v64, 16, v24
    v_and_b32 v65, 0xffff0000, v24
    v_pk_add_f32 v[64:65], v[64:65], v[12:13]
    v_pk_fma_f32 v[44:45], v[64:65], v[64:65], v[44:45]
    v_lshlrev_b32 v66, 16, v25
    v_and_b32 v67, 0xffff0000, v25
    v_pk_add_f32 v[66:67], v[66:67], v[12:13]
    v_pk_fma_f32 v[44:45], v[66:67], v[66:67], v[44:45]
    v_lshlrev_b32 v68, 16, v26
    v_and_b32 v69, 0xffff0000, v26
    v_pk_add_f32 v[68:69], v[68:69], v[12:13]
    v_pk_fma_f32 v[44:45], v[68:69], v[68:69], v[44:45]
    v_lshlrev_b32 v70, 16, v27
    v_and_b32 v71, 0xffff0000, v27
    v_pk_add_f32 v[70:71], v[70:71], v[12:13]
    v_pk_fma_f32 v[44:45], v[70:71], v[70:71], v[44:45]
    v_lshlrev_b32 v72, 16, v28
    v_and_b32 v73, 0xffff0000, v28
    v_pk_add_f32 v[72:73], v[72:73], v[12:13]
    v_pk_fma_f32 v[44:45], v[72:73], v[72:73], v[44:45]
    v_lshlrev_b32 v74, 16, v29
    v_and_b32 v75, 0xffff0000, v29
    v_pk_add_f32 v[74:75], v[74:75], v[12:13]
    v_pk_fma_f32 v[44:45], v[74:75], v[74:75], v[44:45]
    v_lshlrev_b32 v76, 16, v30
    v_and_b32 v77, 0xffff0000, v30
    v_pk_add_f32 v[76:77], v[76:77], v[12:13]
    v_pk_fma_f32 v[44:45], v[76:77], v[76:77], v[44:45]
    v_lshlrev_b32 v78, 16, v31
    v_and_b32 v79, 0xffff0000, v31
    v_pk_add_f32 v[78:79], v[78:79], v[12:13]
    v_pk_fma_f32 v[44:45], v[78:79], v[78:79], v[44:45]
    v_add_f32 v12, v44, v45
    s_nop 1
    v_add_f32_dpp v12, v12, v12 row_ror:1 row_mask:0xf bank_mask:0xf
    s_nop 1
    v_add_f32_dpp v12, v12, v12 row_ror:2 row_mask:0xf bank_mask:0xf
    s_nop 1
    v_add_f32_dpp v12, v12, v12 row_ror:4 row_mask:0xf bank_mask:0xf
    s_nop 1
    v_add_f32_dpp v12, v12, v12 row_ror:8 row_mask:0xf bank_mask:0xf
    v_mov_b32 v13, 0x3727c5ac
    v_fmac_f32 v13, 0x3b000000, v12
    v_rsq_f32 v12, v13
    v_lshlrev_b32 v6, 2, v2
    v_add_u32 v6, 137216, v6
    v_mul_f32 v12, 0x3e0293ee, v12
    ds_write_b32 v6, v12
L_noln:
    v_lshlrev_b32 v6, 2, v4
    v_add_u32 v6, 137216, v6
    s_waitcnt vmcnt(0) lgkmcnt(0)
    s_add_u32 m0, s63, 36864
    s_nop 0
    buffer_load_dwordx4 v7, s[20:23], s64 offen lds
    s_add_u32 s64, s64, 0x8000
    s_add_u32 m0, s63, 37952
    s_nop 0
    buffer_load_dwordx4 v7, s[20:23], s64 offen lds
    s_add_u32 s64, s64, 0x8000
    s_add_u32 m0, s63, 39040
    s_nop 0
    buffer_load_dwordx4 v7, s[20:23], s64 offen lds
    s_add_u32 s64, s64, 0x8000
    s_add_u32 m0, s63, 40128
    s_nop 0
    buffer_load_dwordx4 v7, s[20:23], s64 offen lds
    s_barrier
    ds_read_b64 v[32:33], v14 offset:0
    ds_read_b64_tr_b16 v[80:81], v9 offset:0
    ds_read_b64 v[34:35], v14 offset:32
    ds_read_b64_tr_b16 v[82:83], v9 offset:4608
    ds_read_b64 v[36:37], v14 offset:64
    ds_read_b64_tr_b16 v[84:85], v9 offset:9216
    ds_read_b64 v[38:39], v14 offset:96
    ds_read_b64_tr_b16 v[86:87], v9 offset:13824
    ds_read_b64 v[40:41], v14 offset:128
    ds_read_b64_tr_b16 v[88:89], v9 offset:18432
    ds_read_b64 v[42:43], v14 offset:160
    ds_read_b64_tr_b16 v[90:91], v9 offset:23040
    ds_read_b64 v[44:45], v14 offset:192
    ds_read_b64_tr_b16 v[92:93], v9 offset:27648
    ds_read_b64 v[46:47], v14 offset:224
    ds_read_b64_tr_b16 v[94:95], v9 offset:32256
    s_waitcnt lgkmcnt(12)
    v_mfma_f32_16x16x32_bf16 v[112:115], v[80:83], v[32:35], 0
    s_waitcnt lgkmcnt(8)
    v_mfma_f32_16x16x32_bf16 v[112:115], v[84:87], v[36:39], v[112:115]
    s_waitcnt lgkmcnt(4)
    v_mfma_f32_16x16x32_bf16 v[112:115], v[88:91], v[40:43], v[112:115]
    s_waitcnt lgkmcnt(0)
    v_mfma_f32_16x16x32_bf16 v[112:115], v[92:95], v[44:47], v[112:115]
    ds_read_b32 v12, v6
    s_mov_b32 exec_lo, 0x000f000f
    s_mov_b32 exec_hi, 0x000f000f
    s_nop 4
    v_cvt_pk_bf16_f32 v120, v112, v113
    v_cvt_pk_bf16_f32 v121, v114, v115
    buffer_store_dwordx4 v[120:123], v11, s[48:51], s66 offen
    s_mov_b64 exec, -1
    s_lshl_b32 s69, s57, 17
    s_lshl_b32 s62, s58, 15
    s_add_u32 s69, s69, s62
    s_add_u32 s69, s69, 29696
    s_lshr_b32 s62, s3, 2
    s_mul_i32 s62, s62, 1536
    s_add_u32 s69, s69, s62
    v_lshlrev_b32 v156, 7, v1
    s_mov_b32 s60, 0
    buffer_load_dwordx4 v[128:131], v228, s[48:51], s65 offen sc1
    s_waitcnt vmcnt(1)
    ds_read_b64 v[96:97], v10 offset:36864
    ds_read_b64 v[98:99], v124 offset:36864
    ds_read_b64 v[100:101], v10 offset:36928
    ds_read_b64 v[102:103], v124 offset:36928
    ds_read_b64 v[104:105], v10 offset:36992
    ds_read_b64 v[106:107], v124 offset:36992
    ds_read_b64 v[108:109], v10 offset:37056
    ds_read_b64 v[110:111], v124 offset:37056
Lpoll_2:
    s_waitcnt vmcnt(0)
    v_cmp_ne_u32 vcc, v131, v15
    s_nop 0
    s_cmp_eq_u64 vcc, 0
    s_cbranch_scc1 Lpok_3
    s_add_u32 s60, s60, 1
    s_cmp_lg_u32 s60, 5
    s_cbranch_scc1 Lnl_4
    s_mov_b32 exec_lo, 0x000f000f
    s_mov_b32 exec_hi, 0x000f000f
    buffer_store_dwordx4 v[120:123], v11, s[48:51], s68 offen sc1
    s_mov_b64 exec, -1
Lnl_4:
    s_cmp_lt_u32 s60, 8
    s_cbranch_scc1 Lnt_1
    s_xor_b32 s65, s65, 786432
Lnt_1:
    buffer_load_dwordx4 v[128:131], v228, s[48:51], s65 offen sc1
    s_cmp_lt_u32 s60, 200000
    s_cbranch_scc1 Lpoll_2
    s_waitcnt vmcnt(0)
Lpok_3:
    ds_write_b64 v126, v[128:129]
    s_mov_b32 exec_lo, 0x000f000f
    s_mov_b32 exec_hi, 0x000f000f
    buffer_store_dwordx4 v[120:123], v11, s[48:51], s68 offen sc1
    s_mov_b64 exec, -1
    s_waitcnt lgkmcnt(0)
    s_barrier
    ds_read_b128 v[136:139], v125 offset:0
    ds_read_b128 v[140:143], v125 offset:1024
    ds_read_b128 v[144:147], v125 offset:2048
    ds_read_b128 v[148:151], v125 offset:3072
    s_mov_b32 exec_lo, 0xfff
    s_mov_b32 exec_hi, 0
    buffer_load_dword v200, v156, s[12:15], s69 offen
    s_mov_b64 exec, -1
    s_waitcnt lgkmcnt(3)
    v_mfma_f32_16x16x32_bf16 v[112:115], v[96:99], v[136:139], 0
    s_waitcnt lgkmcnt(2)
    v_mfma_f32_16x16x32_bf16 v[112:115], v[100:103], v[140:143], v[112:115]
    s_waitcnt lgkmcnt(1)
    v_mfma_f32_16x16x32_bf16 v[112:115], v[104:107], v[144:147], v[112:115]
    s_waitcnt lgkmcnt(0)
    v_mfma_f32_16x16x32_bf16 v[112:115], v[108:111], v[148:151], v[112:115]
    s_nop 7
    v_add_f32_dpp v112, v112, v112 row_ror:4 row_mask:0xf bank_mask:0xf
    v_add_f32_dpp v113, v113, v113 row_ror:4 row_mask:0xf bank_mask:0xf
    v_add_f32_dpp v114, v114, v114 row_ror:4 row_mask:0xf bank_mask:0xf
    v_add_f32_dpp v115, v115, v115 row_ror:4 row_mask:0xf bank_mask:0xf
    v_add_f32_dpp v112, v112, v112 row_ror:8 row_mask:0xf bank_mask:0xf
    v_add_f32_dpp v113, v113, v113 row_ror:8 row_mask:0xf bank_mask:0xf
    v_add_f32_dpp v114, v114, v114 row_ror:8 row_mask:0xf bank_mask:0xf
    v_add_f32_dpp v115, v115, v115 row_ror:8 row_mask:0xf bank_mask:0xf
    v_mul_f32 v112, v12, v112
    v_mul_f32 v113, v12, v113
    v_mul_f32 v114, v12, v114
    v_mul_f32 v115, v12, v115
    v_add_u32 v112, 0x10000, v112
    v_add_u32 v113, 0x10000, v113
    v_add_u32 v114, 0x10000, v114
    v_add_u32 v115, 0x10000, v115
    v_perm_b32 v116, v113, v112, s86
    v_perm_b32 v117, v115, v114, s86
    v_bfi_b32 v116, s83, v154, v116
    v_bfi_b32 v117, s83, v155, v117
    ds_write_b64 v152, v[116:117]
    s_cmp_lt_u32 s3, 4
    s_waitcnt lgkmcnt(0)
    s_barrier
    s_cbranch_scc1 L_stream
    s_cmp_lg_u32 s3, 4
    s_cbranch_scc1 L_qgather
    ds_read_b128 v[116:119], v153
    s_waitcnt lgkmcnt(0)
    buffer_store_dwordx4 v[116:119], v127, s[48:51], s67 offen sc1
L_qgather:
    v_lshl_add_u32 v229, v2, 2, v5
    v_mul_u32_u24 v229, 1056, v229
    v_lshl_add_u32 v229, v4, 3, v229
    s_lshl_b32 s61, s3, 7
    v_add_u32 v229, s61, v229
    v_add_u32 v230, 67584, v229
    v_add_u32 v231, 135168, v228
    s_lshl_b32 s61, s3, 11
    s_add_u32 s61, s61, 139264
    v_add_u32 v233, s61, v228
    v_lshl_add_u32 v9, v3, 7, s61
    v_lshlrev_b32 v6, 1, v2
    v_xor_b32 v6, v6, v3
    v_and_b32 v6, 7, v6
    v_lshl_add_u32 v252, v6, 4, v9
    v_xor_b32 v253, 16, v252
    v_lshrrev_b32 v6, 3, v1
    v_xor_b32 v7, v6, v1
    v_and_b32 v7, 7, v7
    v_lshlrev_b32 v7, 4, v7
    v_lshl_add_u32 v232, v6, 17, v7
    s_lshl_b32 s72, s56, 21
    s_lshl_b32 s62, s3, 14
    s_add_u32 s72, s72, s62
    s_lshl_b32 s62, s57, 7
    s_add_u32 s72, s72, s62
    s_add_u32 s72, s72, 4194304
    s_lshl1_add_u32 s63, s54, s56
    s_lshl_b32 s65, s63, 14
    s_add_u32 s65, s65, 786432
    v_add_u32 v11, 139264, v228
    s_lshl2_add_u32 s64, s58, s59
    s_add_u32 s61, s64, 0
    s_and_b32 s61, s61, 15
    s_lshl_b32 s62, s61, 10
    s_add_u32 s16, s62, s65
    s_mul_i32 s61, s61, 1056
    v_add_u32 v160, s61, v11
    v_lshl_add_u32 v6, v4, 2, 0
    v_lshrrev_b32 v6, v6, v15
    v_and_b32 v164, 0x00010001, v6
    s_add_u32 s61, s64, 1
    s_and_b32 s61, s61, 15
    s_lshl_b32 s62, s61, 10
    s_add_u32 s17, s62, s65
    s_mul_i32 s61, s61, 1056
    v_add_u32 v161, s61, v11
    v_lshl_add_u32 v6, v4, 2, 1
    v_lshrrev_b32 v6, v6, v15
    v_and_b32 v165, 0x00010001, v6
    s_add_u32 s61, s64, 2
    s_and_b32 s61, s61, 15
    s_lshl_b32 s62, s61, 10
    s_add_u32 s18, s62, s65
    s_mul_i32 s61, s61, 1056
    v_add_u32 v162, s61, v11
    v_lshl_add_u32 v6, v4, 2, 2
    v_lshrrev_b32 v6, v6, v15
    v_and_b32 v166, 0x00010001, v6
    s_add_u32 s61, s64, 3
    s_and_b32 s61, s61, 15
    s_lshl_b32 s62, s61, 10
    s_add_u32 s19, s62, s65
    s_mul_i32 s61, s61, 1056
    v_add_u32 v163, s61, v11
    v_lshl_add_u32 v6, v4, 2, 3
    v_lshrrev_b32 v6, v6, v15
    v_and_b32 v167, 0x00010001, v6
    s_lshl_b32 s61, s58, 2
    s_add_u32 s61, s61, 102400
    v_mov_b32 v12, s61
    v_and_b32 v9, 1, v1
    v_lshlrev_b32 v9, 7, v9
    v_lshrrev_b32 v13, 1, v1
    v_lshl_add_u32 v10, v13, 10, v9
    v_lshlrev_b32 v9, 4, v3
    v_lshl_add_u32 v9, v2, 13, v9
    s_lshl_b32 s67, s53, 20
    s_lshl_b32 s62, s58, 18
    s_add_u32 s67, s67, s62
    s_lshl_b32 s62, s52, 8
    s_add_u32 s67, s67, s62
    s_lshl_b32 s68, s52, 17
    s_lshl_b32 s62, s58, 15
    s_add_u32 s68, s68, s62
    s_lshl_b32 s62, s53, 8
    s_add_u32 s68, s68, s62
    s_lshl_b32 s61, s52, 13
    s_lshl_b32 s62, s53, 11
    s_add_u32 s61, s61, s62
    s_lshl_b32 s62, s58, 9
    s_add_u32 s61, s61, s62
    s_add_u32 s61, s61, 1310720
    s_lshr_b32 s63, s52, 4
    s_and_b32 s64, s52, 15
    s_lshl_b32 s65, s63, 15
    s_lshl_b32 s62, s58, 13
    s_add_u32 s65, s65, s62
    s_lshl_b32 s62, s64, 4
    s_add_u32 s65, s65, s62
    s_add_u32 s65, s65, 1048576
    s_cmp_lg_u32 s56, 0
    s_cbranch_scc1 L_nopre
    v_lshlrev_b32 v8, 7, v4
    buffer_load_dword v47, v8, s[48:51], s61 offen sc1
    v_and_b32 v8, 1, v1
    v_lshlrev_b32 v8, 8, v8
    s_lshl_b32 s61, s63, 15
    s_lshl_b32 s62, s59, 11
    s_add_u32 s61, s61, s62
    s_lshl_b32 s62, s58, 9
    s_add_u32 s61, s61, s62
    s_lshl_b32 s62, s64, 4
    s_add_u32 s61, s61, s62
    s_add_u32 s61, s61, 1048576
    buffer_load_dword v46, v8, s[48:51], s61 offen sc1
L_nopre:
    s_mov_b32 s60, 0
    v_mov_b32 v55, 102416
Llw_5:
    ds_read_b32 v48, v55
    s_waitcnt lgkmcnt(0)
    v_cmp_ne_u32 vcc, -1, v48
    s_nop 0
    s_cmp_eq_u64 vcc, 0
    s_cbranch_scc1 Llok_6
    s_sleep 1
    s_add_u32 s60, s60, 1
    s_cmp_lt_u32 s60, 1600000
    s_cbranch_scc1 Llw_5
Llok_6:
    s_mov_b32 s60, 0
    buffer_load_dwordx4 v[16:19], v228, s[48:51], s16 offen sc1
    buffer_load_dwordx4 v[20:23], v228, s[48:51], s17 offen sc1
    buffer_load_dwordx4 v[24:27], v228, s[48:51], s18 offen sc1
    buffer_load_dwordx4 v[28:31], v228, s[48:51], s19 offen sc1
    v_add_u32 v195, 122880, v228
    v_lshlrev_b32 v198, 8, v2
    v_lshl_add_u32 v198, v4, 4, v198
    v_lshl_add_u32 v7, v2, 2, v5
    v_mul_u32_u24 v199, 4736, v2
    v_mul_u32_u24 v6, 288, v5
    v_add_u32 v199, v199, v6
    v_lshl_add_u32 v199, v4, 3, v199
    s_lshl_b32 s61, s3, 5
    v_add_u32 v199, s61, v199
    v_lshlrev_b32 v7, 6, v7
    v_lshl_add_u32 v7, v4, 3, v7
    v_and_b32 v6, 1, v2
    v_lshl_add_u32 v7, v6, 5, v7
    s_lshl_b32 s61, s3, 12
    s_add_u32 s61, s61, 40960
    v_add_u32 v200, s61, v7
    v_xor_b32 v201, 32, v200
    s_lshl_b32 s61, s3, 10
    s_add_u32 s61, s61, 126976
    v_add_u32 v202, s61, v228
    v_lshrrev_b32 v6, 1, v5
    v_lshl_add_u32 v203, v6, 12, v228
    v_add_u32 v203, 126976, v203
    v_and_b32 v6, 7, v1
    v_lshlrev_b32 v6, 4, v6
    v_lshl_add_u32 v204, v2, 10, v6
    s_lshl_b32 s76, s55, 15
    s_lshl_b32 s62, s3, 12
    s_add_u32 s76, s76, s62
    s_add_u32 s76, s76, 1310720
    s_lshl_b32 s77, s52, 13
    s_lshl_b32 s62, s3, 10
    s_add_u32 s77, s77, s62
    s_lshl_b32 s62, s53, 6
    s_add_u32 s77, s77, s62
    s_add_u32 s77, s77, 1310720
    s_lshl_b32 s79, s59, 12
    s_lshl_b32 s62, s55, 7
    s_add_u32 s79, s79, s62
    s_add_u32 s79, s79, 1114112
    s_lshl_b32 s78, s55, 7
    s_lshl_b32 s62, s59, 2
    s_add_u32 s78, s78, s62
    s_add_u32 s78, s78, 1249280
    v_mov_b32 v184, s4
    v_mov_b32 v185, s4
    v_mov_b32 v186, s4
    v_mov_b32 v187, s4
    v_mov_b32 v188, s4
    v_mov_b32 v189, s4
    s_lshl2_add_u32 s63, s52, s53
    s_lshl3_add_u32 s63, s63, s58
    s_lshl_b32 s66, s63, 12
    s_add_u32 s66, s66, 4194304
    v_and_b32 v6, 31, v1
    v_lshlrev_b32 v192, 8, v6
    s_lshl_b32 s85, s58, 13
    s_add_u32 s85, s85, 73728
    s_cmp_lt_u32 s3, 4
    s_cselect_b32 s61, 0x1000, 0
    s_add_u32 s86, s85, s61
    s_lshl2_add_u32 s87, s61, s66
    s_lshr_b32 s61, s61, 1
    v_add_u32 v205, s61, v195
    s_lshl_b32 s61, s58, 6
    s_add_u32 s61, s61, 135168
    v_lshl_add_u32 v196, v6, 1, s61
    v_lshl_add_u32 v197, v2, 3, s61
    s_lshl_b32 s84, 0x11111111, s58
    v_mul_u32_u24 v212, 288, v2
    v_lshl_add_u32 v212, v3, 4, v212
    s_mul_i32 s61, s58, 9472
    v_add_u32 v212, s61, v212
    v_lshlrev_b32 v6, 5, v2
    v_xor_b32 v193, v6, v228
    v_lshrrev_b32 v6, 3, v1
    v_lshlrev_b32 v194, v6, 1
    v_lshrrev_b32 v6, 1, v3
    v_and_b32 v7, 1, v3
    v_lshl_add_u32 v6, v7, 4, v6
    v_bfe_u32 v7, v15, v6, 1
    v_mul_u32_u24 v210, 0x10001, v7
    v_add_u32 v6, 8, v6
    v_bfe_u32 v7, v15, v6, 1
    v_mul_u32_u24 v211, 0x10001, v7
    v_lshl_add_u32 v6, v2, 2, v5
    v_bfe_u32 v7, v6, 1, 2
    v_lshl_add_u32 v6, v6, 7, s86
    v_lshl_add_u32 v6, v4, 3, v6
    v_xor_b32 v206, 0, v7
    v_lshl_add_u32 v206, v206, 5, v6
    v_xor_b32 v207, 1, v7
    v_lshl_add_u32 v207, v207, 5, v6
    v_xor_b32 v208, 2, v7
    v_lshl_add_u32 v208, v208, 5, v6
    v_xor_b32 v209, 3, v7
    v_lshl_add_u32 v209, v209, 5, v6
L_qp:
    v_mov_b32 v48, 0
    s_waitcnt vmcnt(3)
    v_xor_b32 v16, v16, v164
    v_xor_b32 v17, v17, v165
    v_xor_b32 v18, v18, v166
    v_xor_b32 v19, v19, v167
    ds_write_b128 v160, v[16:19]
    v_or3_b32 v48, v48, v16, v17
    v_or3_b32 v48, v48, v18, v19
    s_waitcnt vmcnt(2)
    v_xor_b32 v20, v20, v164
    v_xor_b32 v21, v21, v165
    v_xor_b32 v22, v22, v166
    v_xor_b32 v23, v23, v167
    ds_write_b128 v161, v[20:23]
    v_or3_b32 v48, v48, v20, v21
    v_or3_b32 v48, v48, v22, v23
    s_waitcnt vmcnt(1)
    v_xor_b32 v24, v24, v164
    v_xor_b32 v25, v25, v165
    v_xor_b32 v26, v26, v166
    v_xor_b32 v27, v27, v167
    ds_write_b128 v162, v[24:27]
    v_or3_b32 v48, v48, v24, v25
    v_or3_b32 v48, v48, v26, v27
    s_waitcnt vmcnt(0)
    v_xor_b32 v28, v28, v164
    v_xor_b32 v29, v29, v165
    v_xor_b32 v30, v30, v166
    v_xor_b32 v31, v31, v167
    ds_write_b128 v163, v[28:31]
    v_or3_b32 v48, v48, v28, v29
    v_or3_b32 v48, v48, v30, v31
    v_and_b32 v48, s83, v48
    v_cmp_ne_u32 vcc, 0, v48
    s_nop 0
    s_cmp_eq_u64 vcc, 0
    s_cbranch_scc1 L_qok
    s_add_u32 s60, s60, 1
    s_sleep 4
    s_waitcnt lgkmcnt(0)
    buffer_load_dwordx4 v[16:19], v228, s[48:51], s16 offen sc1
    buffer_load_dwordx4 v[20:23], v228, s[48:51], s17 offen sc1
    buffer_load_dwordx4 v[24:27], v228, s[48:51], s18 offen sc1
    buffer_load_dwordx4 v[28:31], v228, s[48:51], s19 offen sc1
    s_cmp_lt_u32 s60, 200000
    s_cbranch_scc1 L_qp
L_qok:
    v_mov_b32 v48, -1
    s_waitcnt lgkmcnt(0)
    ds_write_b32 v12, v48
    v_mov_b32 v213, v9
    v_mov_b32 v214, v10
    s_lshl_b32 s61, s55, 8
    s_add_u32 s61, s61, 1245184
    v_and_b32 v6, 31, v1
    v_lshlrev_b32 v6, 3, v6
    buffer_load_dwordx2 v[180:181], v6, s[48:51], s61 offen sc1
    s_cmp_lg_u32 s56, 0
    s_cbranch_scc1 L_nolate
    buffer_load_dwordx4 v[124:127], v213, s[24:27], s67 offen
    s_add_u32 s67, s67, 0x8000
    buffer_load_dwordx4 v[128:131], v213, s[24:27], s67 offen
    s_add_u32 s67, s67, 0x8000
    buffer_load_dwordx4 v[132:135], v213, s[24:27], s67 offen
    s_add_u32 s67, s67, 0x8000
    buffer_load_dwordx4 v[136:139], v213, s[24:27], s67 offen
    s_add_u32 s67, s67, 0x8000
    buffer_load_dwordx4 v[140:143], v213, s[24:27], s67 offen
    s_add_u32 s67, s67, 0x8000
    buffer_load_dwordx4 v[144:147], v213, s[24:27], s67 offen
    s_add_u32 s67, s67, 0x8000
    buffer_load_dwordx4 v[148:151], v213, s[24:27], s67 offen
    s_add_u32 s67, s67, 0x8000
    buffer_load_dwordx4 v[152:155], v213, s[24:27], s67 offen
    s_branch L_late_done
L_nolate:
    buffer_load_dword v124, v214, s[28:31], s68 offen
L_late_done:
    v_and_b32 v6, 1, v2
    v_lshlrev_b32 v6, 3, v6
    v_lshrrev_b32 v6, v6, v15
    v_lshrrev_b32 v7, 1, v6
    v_lshrrev_b32 v10, 2, v6
    v_lshrrev_b32 v11, 3, v6
    v_lshrrev_b32 v224, 4, v6
    v_lshrrev_b32 v225, 5, v6
    v_lshrrev_b32 v226, 6, v6
    v_lshrrev_b32 v227, 7, v6
    s_waitcnt lgkmcnt(0)
    s_barrier
    ds_read_b64_tr_b16 v[16:17], v229 offset:0
    ds_read_b64_tr_b16 v[18:19], v229 offset:16896
    ds_read_b64_tr_b16 v[20:21], v229 offset:32
    ds_read_b64_tr_b16 v[22:23], v229 offset:16928
    ds_read_b64_tr_b16 v[24:25], v229 offset:64
    ds_read_b64_tr_b16 v[26:27], v229 offset:16960
    ds_read_b64_tr_b16 v[28:29], v229 offset:96
    ds_read_b64_tr_b16 v[30:31], v229 offset:16992
    ds_read_b64_tr_b16 v[32:33], v229 offset:33792
    ds_read_b64_tr_b16 v[34:35], v229 offset:50688
    ds_read_b64_tr_b16 v[36:37], v229 offset:33824
    ds_read_b64_tr_b16 v[38:39], v229 offset:50720
    ds_read_b64_tr_b16 v[40:41], v229 offset:33856
    ds_read_b64_tr_b16 v[42:43], v229 offset:50752
    ds_read_b64_tr_b16 v[44:45], v229 offset:33888
    ds_read_b64_tr_b16 v[46:47], v229 offset:50784
    ds_read_b64_tr_b16 v[48:49], v230 offset:0
    ds_read_b64_tr_b16 v[50:51], v230 offset:16896
    ds_read_b64_tr_b16 v[52:53], v230 offset:32
    ds_read_b64_tr_b16 v[54:55], v230 offset:16928
    ds_read_b64_tr_b16 v[56:57], v230 offset:64
    ds_read_b64_tr_b16 v[58:59], v230 offset:16960
    ds_read_b64_tr_b16 v[60:61], v230 offset:96
    ds_read_b64_tr_b16 v[62:63], v230 offset:16992
    ds_read_b64_tr_b16 v[64:65], v230 offset:33792
    ds_read_b64_tr_b16 v[66:67], v230 offset:50688
    ds_read_b64_tr_b16 v[68:69], v230 offset:33824
    ds_read_b64_tr_b16 v[70:71], v230 offset:50720
    ds_read_b64_tr_b16 v[72:73], v230 offset:33856
    ds_read_b64_tr_b16 v[74:75], v230 offset:50752
    ds_read_b64_tr_b16 v[76:77], v230 offset:33888
    ds_read_b64_tr_b16 v[78:79], v230 offset:50784
    s_barrier
    ds_read_b128 v[80:83], v231 offset:0
    ds_read_b128 v[84:87], v231 offset:1024
    ds_read_b128 v[88:91], v231 offset:2048
    ds_read_b128 v[92:95], v231 offset:3072
    s_waitcnt lgkmcnt(3)
    v_mfma_f32_16x16x32_bf16 v[96:99], v[16:19], v[80:83], 0
    v_mfma_f32_16x16x32_bf16 v[100:103], v[20:23], v[80:83], 0
    v_mfma_f32_16x16x32_bf16 v[104:107], v[24:27], v[80:83], 0
    v_mfma_f32_16x16x32_bf16 v[108:111], v[28:31], v[80:83], 0
    s_waitcnt lgkmcnt(2)
    v_mfma_f32_16x16x32_bf16 v[96:99], v[32:35], v[84:87], v[96:99]
    v_mfma_f32_16x16x32_bf16 v[100:103], v[36:39], v[84:87], v[100:103]
    v_mfma_f32_16x16x32_bf16 v[104:107], v[40:43], v[84:87], v[104:107]
    v_mfma_f32_16x16x32_bf16 v[108:111], v[44:47], v[84:87], v[108:111]
    s_waitcnt lgkmcnt(1)
    v_mfma_f32_16x16x32_bf16 v[96:99], v[48:51], v[88:91], v[96:99]
    v_mfma_f32_16x16x32_bf16 v[100:103], v[52:55], v[88:91], v[100:103]
    v_mfma_f32_16x16x32_bf16 v[104:107], v[56:59], v[88:91], v[104:107]
    v_mfma_f32_16x16x32_bf16 v[108:111], v[60:63], v[88:91], v[108:111]
    s_waitcnt lgkmcnt(0)
    v_mfma_f32_16x16x32_bf16 v[96:99], v[64:67], v[92:95], v[96:99]
    v_mfma_f32_16x16x32_bf16 v[100:103], v[68:71], v[92:95], v[100:103]
    v_mfma_f32_16x16x32_bf16 v[104:107], v[72:75], v[92:95], v[104:107]
    v_mfma_f32_16x16x32_bf16 v[108:111], v[76:79], v[92:95], v[108:111]
L_pvout:
    s_nop 4
    v_cvt_pk_bf16_f32 v112, v96, v97
    v_bfi_b32 v112, s83, v6, v112
    v_cvt_pk_bf16_f32 v113, v98, v99
    v_bfi_b32 v113, s83, v7, v113
    v_cvt_pk_bf16_f32 v114, v100, v101
    v_bfi_b32 v114, s83, v10, v114
    v_cvt_pk_bf16_f32 v115, v102, v103
    v_bfi_b32 v115, s83, v11, v115
    ds_write_b128 v252, v[112:115]
    v_cvt_pk_bf16_f32 v116, v104, v105
    v_bfi_b32 v116, s83, v224, v116
    v_cvt_pk_bf16_f32 v117, v106, v107
    v_bfi_b32 v117, s83, v225, v117
    v_cvt_pk_bf16_f32 v118, v108, v109
    v_bfi_b32 v118, s83, v226, v118
    v_cvt_pk_bf16_f32 v119, v110, v111
    v_bfi_b32 v119, s83, v227, v119
    ds_write_b128 v253, v[116:119]
    s_add_u32 s61, s72, 0x100000
    s_waitcnt lgkmcnt(0)
    ds_read_b128 v[16:19], v233 offset:0
    ds_read_b128 v[20:23], v233 offset:1024
    s_waitcnt lgkmcnt(1)
    buffer_store_dwordx4 v[16:19], v232, s[48:51], s72 offen sc1
    s_waitcnt lgkmcnt(0)
    buffer_store_dwordx4 v[20:23], v232, s[48:51], s61 offen sc1
    s_cmp_ge_u32 s3, 4
    s_barrier
    s_cbranch_scc1 L_nostore
    s_cmp_lg_u32 s56, 0
    s_cbranch_scc1 L_g1w03
    v_lshrrev_b32 v6, 2, v1
    v_and_b32 v7, 1, v2
    v_lshlrev_b32 v7, 1, v7
    v_xor_b32 v7, v7, v4
    v_lshlrev_b32 v7, 4, v7
    v_lshl_add_u32 v6, v6, 10, v7
    s_lshl_b32 s64, s3, 12
    s_lshl_b32 s61, s55, 19
    s_lshl_b32 s62, s3, 16
    s_add_u32 s61, s61, s62
    s_lshl_b32 s62, s59, 6
    s_add_u32 s61, s61, s62
    s_add_u32 m0, s64, 40960
    s_nop 0
    buffer_load_dwordx4 v6, s[28:31], s61 offen lds
    s_add_u32 s61, s61, 0x4000
    s_add_u32 m0, s64, 41984
    s_nop 0
    buffer_load_dwordx4 v6, s[28:31], s61 offen lds
    s_add_u32 s61, s61, 0x4000
    s_add_u32 m0, s64, 43008
    s_nop 0
    buffer_load_dwordx4 v6, s[28:31], s61 offen lds
    s_add_u32 s61, s61, 0x4000
    s_add_u32 m0, s64, 44032
    s_nop 0
    buffer_load_dwordx4 v6, s[28:31], s61 offen lds
    v_bfe_u32 v6, v1, 2, 1
    v_cmp_eq_u32 s[70:71], 1, v6
    v_and_b32 v9, 1, v4
    v_lshlrev_b32 v9, 4, v9
    v_mov_b32 v10, 0x3f80
    v_lshlrev_b32 v10, v9, v10
    v_cmp_gt_u32 vcc, 2, v4
    s_nop 1
    v_cndmask_b32 v216, 0, v10, vcc
    v_cndmask_b32 v217, v10, 0, vcc
    v_mov_b32 v218, v216
    v_mov_b32 v219, v217
    v_mov_b32 v132, 0
    v_mov_b32 v133, 0
    v_mov_b32 v156, 0
    v_mov_b32 v157, 0
    s_lshl_b32 s61, s55, 8
    s_add_u32 s61, s61, 1245184
    v_and_b32 v6, 31, v1
    v_lshlrev_b32 v6, 3, v6
    buffer_load_dwordx2 v[180:181], v6, s[48:51], s61 offen sc1
    v_add_u32 v195, 122880, v228
    v_lshlrev_b32 v198, 8, v2
    v_lshl_add_u32 v198, v4, 4, v198
    v_lshl_add_u32 v7, v2, 2, v5
    v_mul_u32_u24 v199, 4736, v2
    v_mul_u32_u24 v6, 288, v5
    v_add_u32 v199, v199, v6
    v_lshl_add_u32 v199, v4, 3, v199
    s_lshl_b32 s61, s3, 5
    v_add_u32 v199, s61, v199
    v_lshlrev_b32 v7, 6, v7
    v_lshl_add_u32 v7, v4, 3, v7
    v_and_b32 v6, 1, v2
    v_lshl_add_u32 v7, v6, 5, v7
    s_lshl_b32 s61, s3, 12
    s_add_u32 s61, s61, 40960
    v_add_u32 v200, s61, v7
    v_xor_b32 v201, 32, v200
    s_lshl_b32 s61, s3, 10
    s_add_u32 s61, s61, 126976
    v_add_u32 v202, s61, v228
    v_lshrrev_b32 v6, 1, v5
    v_lshl_add_u32 v203, v6, 12, v228
    v_add_u32 v203, 126976, v203
    v_and_b32 v6, 7, v1
    v_lshlrev_b32 v6, 4, v6
    v_lshl_add_u32 v204, v2, 10, v6
    s_lshl_b32 s76, s55, 15
    s_lshl_b32 s62, s3, 12
    s_add_u32 s76, s76, s62
    s_add_u32 s76, s76, 1310720
    s_lshl_b32 s77, s52, 13
    s_lshl_b32 s62, s3, 10
    s_add_u32 s77, s77, s62
    s_lshl_b32 s62, s53, 6
    s_add_u32 s77, s77, s62
    s_add_u32 s77, s77, 1310720
    s_lshl_b32 s79, s59, 12
    s_lshl_b32 s62, s55, 7
    s_add_u32 s79, s79, s62
    s_add_u32 s79, s79, 1114112
    s_lshl_b32 s78, s55, 7
    s_lshl_b32 s62, s59, 2
    s_add_u32 s78, s78, s62
    s_add_u32 s78, s78, 1249280
    v_mov_b32 v184, s4
    v_mov_b32 v185, s4
    v_mov_b32 v186, s4
    v_mov_b32 v187, s4
    v_mov_b32 v188, s4
    v_mov_b32 v189, s4
    s_lshl2_add_u32 s63, s52, s53
    s_lshl3_add_u32 s63, s63, s58
    s_lshl_b32 s66, s63, 12
    s_add_u32 s66, s66, 4194304
    v_and_b32 v6, 31, v1
    v_lshlrev_b32 v192, 8, v6
    s_lshl_b32 s85, s58, 13
    s_add_u32 s85, s85, 73728
    s_cmp_lt_u32 s3, 4
    s_cselect_b32 s61, 0x1000, 0
    s_add_u32 s86, s85, s61
    s_lshl2_add_u32 s87, s61, s66
    s_lshr_b32 s61, s61, 1
    v_add_u32 v205, s61, v195
    s_lshl_b32 s61, s58, 6
    s_add_u32 s61, s61, 135168
    v_lshl_add_u32 v196, v6, 1, s61
    v_lshl_add_u32 v197, v2, 3, s61
    s_lshl_b32 s84, 0x11111111, s58
    v_mul_u32_u24 v212, 288, v2
    v_lshl_add_u32 v212, v3, 4, v212
    s_mul_i32 s61, s58, 9472
    v_add_u32 v212, s61, v212
    v_lshlrev_b32 v6, 5, v2
    v_xor_b32 v193, v6, v228
    v_lshrrev_b32 v6, 3, v1
    v_lshlrev_b32 v194, v6, 1
    v_lshrrev_b32 v6, 1, v3
    v_and_b32 v7, 1, v3
    v_lshl_add_u32 v6, v7, 4, v6
    v_bfe_u32 v7, v15, v6, 1
    v_mul_u32_u24 v210, 0x10001, v7
    v_add_u32 v6, 8, v6
    v_bfe_u32 v7, v15, v6, 1
    v_mul_u32_u24 v211, 0x10001, v7
    v_lshl_add_u32 v6, v2, 2, v5
    v_bfe_u32 v7, v6, 1, 2
    v_lshl_add_u32 v6, v6, 7, s86
    v_lshl_add_u32 v6, v4, 3, v6
    v_xor_b32 v206, 0, v7
    v_lshl_add_u32 v206, v206, 5, v6
    v_xor_b32 v207, 1, v7
    v_lshl_add_u32 v207, v207, 5, v6
    v_xor_b32 v208, 2, v7
    v_lshl_add_u32 v208, v208, 5, v6
    v_xor_b32 v209, 3, v7
    v_lshl_add_u32 v209, v209, 5, v6
    v_lshlrev_b32 v224, 16, v234
    v_and_b32 v225, 0xffff0000, v234
    v_lshlrev_b32 v226, 16, v235
    v_and_b32 v227, 0xffff0000, v235
    s_waitcnt vmcnt(0)
    s_barrier
    s_waitcnt vmcnt(0)
    v_cmp_ne_u32 vcc, s89, v180
    v_cmp_ne_u32 s[6:7], v181, v15
    s_nop 0
    s_or_b64 vcc, vcc, s[6:7]
    s_cselect_b32 s88, 0, 1
    ds_read_b64_tr_b16 v[16:17], v199 offset:0
    ds_read_b64_tr_b16 v[18:19], v199 offset:1152
    ds_read_b64_tr_b16 v[20:21], v199 offset:2304
    ds_read_b64_tr_b16 v[22:23], v199 offset:3456
    ds_read_b64_tr_b16 v[24:25], v199 offset:18944
    ds_read_b64_tr_b16 v[26:27], v199 offset:20096
    ds_read_b64_tr_b16 v[28:29], v199 offset:21248
    ds_read_b64_tr_b16 v[30:31], v199 offset:22400
    s_branch L_bg
L_nostore:
    s_setprio 2
    s_cmp_lg_u32 s56, 0
    s_cbranch_scc1 L_g1tail
    s_waitcnt vmcnt(9)
    ds_write_b128 v212, v[124:127] offset:0
    s_waitcnt vmcnt(8)
    ds_write_b128 v212, v[128:131] offset:1152
    s_waitcnt vmcnt(7)
    ds_write_b128 v212, v[132:135] offset:2304
    s_waitcnt vmcnt(6)
    ds_write_b128 v212, v[136:139] offset:3456
    s_waitcnt vmcnt(5)
    ds_write_b128 v212, v[140:143] offset:4736
    s_waitcnt vmcnt(4)
    ds_write_b128 v212, v[144:147] offset:5888
    s_waitcnt vmcnt(3)
    ds_write_b128 v212, v[148:151] offset:7040
    s_waitcnt vmcnt(2)
    ds_write_b128 v212, v[152:155] offset:8192
    v_cmp_ne_u32 vcc, s89, v180
    v_cmp_ne_u32 s[6:7], v181, v15
    s_nop 0
    s_or_b64 vcc, vcc, s[6:7]
    s_cselect_b32 s88, 0, 1
    s_add_u32 s67, s66, 0x4000
    s_mov_b32 m0, s85
    s_waitcnt lgkmcnt(0)
    s_barrier
    s_mov_b32 s60, 0
    s_mov_b32 exec_lo, -1
    s_mov_b32 exec_hi, 0
    buffer_load_dwordx4 v[48:51], v192, s[48:51], s65 offen sc1
    s_mov_b64 exec, -1
    ds_read_b64_tr_b16 v[16:17], v199 offset:0
    ds_read_b64_tr_b16 v[18:19], v199 offset:1152
    ds_read_b64_tr_b16 v[20:21], v199 offset:2304
    ds_read_b64_tr_b16 v[22:23], v199 offset:3456
    ds_read_b64_tr_b16 v[24:25], v199 offset:18944
    ds_read_b64_tr_b16 v[26:27], v199 offset:20096
    ds_read_b64_tr_b16 v[28:29], v199 offset:21248
    ds_read_b64_tr_b16 v[30:31], v199 offset:22400
    s_mov_b32 exec_lo, -1
    s_mov_b32 exec_hi, 0
Lmp_7:
    s_waitcnt vmcnt(0)
    v_cmp_ne_u32 s[16:17], v51, v15
    s_nop 0
    s_or_b64 s[6:7], s[16:17], s[16:17]
    s_cbranch_scc0 Lmok_8
    s_mov_b64 exec, s[16:17]
    s_cbranch_execz Lsk_9
    buffer_load_dwordx4 v[48:51], v192, s[48:51], s65 offen sc1
Lsk_9:
    s_mov_b32 exec_lo, -1
    s_mov_b32 exec_hi, 0
    s_add_u32 s60, s60, 1
    s_cmp_lt_u32 s60, 200000
    s_cbranch_scc1 Lmp_7
    s_waitcnt vmcnt(0)
Lmok_8:
    s_mov_b64 exec, -1
    buffer_load_dwordx4 v193, s[48:51], s66 offen offset:0 sc1 lds
    buffer_load_dwordx4 v193, s[48:51], s66 offen offset:1024 sc1 lds
    buffer_load_dwordx4 v193, s[48:51], s66 offen offset:2048 sc1 lds
    buffer_load_dwordx4 v193, s[48:51], s66 offen offset:3072 sc1 lds
    s_add_u32 m0, s85, 4096
    s_nop 0
    buffer_load_dwordx4 v193, s[48:51], s67 offen offset:0 sc1 lds
    buffer_load_dwordx4 v193, s[48:51], s67 offen offset:1024 sc1 lds
    buffer_load_dwordx4 v193, s[48:51], s67 offen offset:2048 sc1 lds
    buffer_load_dwordx4 v193, s[48:51], s67 offen offset:3072 sc1 lds
    v_lshrrev_b32 v6, 2, v1
    v_and_b32 v7, 1, v2
    v_lshlrev_b32 v7, 1, v7
    v_xor_b32 v7, v7, v4
    v_lshlrev_b32 v7, 4, v7
    v_lshl_add_u32 v6, v6, 10, v7
    s_lshl_b32 s64, s3, 12
    s_lshl_b32 s61, s55, 19
    s_lshl_b32 s62, s3, 16
    s_add_u32 s61, s61, s62
    s_lshl_b32 s62, s59, 6
    s_add_u32 s61, s61, s62
    s_add_u32 m0, s64, 40960
    s_nop 0
    buffer_load_dwordx4 v6, s[28:31], s61 offen lds
    s_add_u32 s61, s61, 0x4000
    s_add_u32 m0, s64, 41984
    s_nop 0
    buffer_load_dwordx4 v6, s[28:31], s61 offen lds
    s_add_u32 s61, s61, 0x4000
    s_add_u32 m0, s64, 43008
    s_nop 0
    buffer_load_dwordx4 v6, s[28:31], s61 offen lds
    s_add_u32 s61, s61, 0x4000
    s_add_u32 m0, s64, 44032
    s_nop 0
    buffer_load_dwordx4 v6, s[28:31], s61 offen lds
    v_mov_b32 v12, v48
    s_nop 1
    v_max_f32_dpp v12, v12, v12 row_ror:1 row_mask:0xf bank_mask:0xf
    s_nop 1
    v_max_f32_dpp v12, v12, v12 row_ror:2 row_mask:0xf bank_mask:0xf
    s_nop 1
    v_max_f32_dpp v12, v12, v12 row_ror:4 row_mask:0xf bank_mask:0xf
    s_nop 1
    v_max_f32_dpp v12, v12, v12 row_ror:8 row_mask:0xf bank_mask:0xf
    v_mov_b32 v13, v12
    s_nop 1
    v_permlane16_swap_b32 v12, v13
    v_max_f32 v12, v12, v13
    v_sub_f32 v12, v48, v12
    v_exp_f32 v12, v12
    s_nop 0
    v_mul_f32 v13, v12, v49
    s_nop 1
    v_add_f32_dpp v13, v13, v13 row_ror:1 row_mask:0xf bank_mask:0xf
    s_nop 1
    v_add_f32_dpp v13, v13, v13 row_ror:2 row_mask:0xf bank_mask:0xf
    s_nop 1
    v_add_f32_dpp v13, v13, v13 row_ror:4 row_mask:0xf bank_mask:0xf
    s_nop 1
    v_add_f32_dpp v13, v13, v13 row_ror:8 row_mask:0xf bank_mask:0xf
    v_mov_b32 v14, v13
    s_nop 1
    v_permlane16_swap_b32 v13, v14
    v_add_f32 v13, v13, v14
    v_rcp_f32 v13, v13
    v_mul_f32 v12, 0x3f805c29, v12
    v_mul_f32 v12, v12, v13
    v_cvt_pk_bf16_f32 v12, v12, v12
    s_mov_b32 exec_hi, 0
    ds_write_b16 v196, v12
    s_mov_b32 exec_hi, -1
    s_waitcnt vmcnt(4)
    s_setprio 0
L_bg:
    s_mov_b32 s60, 0
    s_waitcnt lgkmcnt(0)
    s_barrier
    ds_read_b64 v[52:53], v197
    ds_read_b64 v[54:55], v197 offset:32
L_h2poll:
    ds_read_b64_tr_b16 v[76:77], v206 offset:0
    ds_read_b64_tr_b16 v[78:79], v206 offset:2048
    ds_read_b64_tr_b16 v[80:81], v207 offset:0
    ds_read_b64_tr_b16 v[82:83], v207 offset:2048
    ds_read_b64_tr_b16 v[84:85], v208 offset:0
    ds_read_b64_tr_b16 v[86:87], v208 offset:2048
    ds_read_b64_tr_b16 v[88:89], v209 offset:0
    ds_read_b64_tr_b16 v[90:91], v209 offset:2048
    v_mov_b32 v14, 0
    s_waitcnt lgkmcnt(6)
    v_xor_b32 v76, v76, v210
    v_xor_b32 v77, v77, v210
    v_xor_b32 v78, v78, v210
    v_xor_b32 v79, v79, v210
    v_or3_b32 v14, v14, v76, v77
    v_or3_b32 v14, v14, v78, v79
    v_mfma_f32_16x16x32_bf16 v[100:103], v[76:79], v[52:55], 0
    s_waitcnt lgkmcnt(4)
    v_xor_b32 v80, v80, v211
    v_xor_b32 v81, v81, v211
    v_xor_b32 v82, v82, v211
    v_xor_b32 v83, v83, v211
    v_or3_b32 v14, v14, v80, v81
    v_or3_b32 v14, v14, v82, v83
    v_mfma_f32_16x16x32_bf16 v[104:107], v[80:83], v[52:55], 0
    s_waitcnt lgkmcnt(2)
    v_xor_b32 v84, v84, v210
    v_xor_b32 v85, v85, v210
    v_xor_b32 v86, v86, v210
    v_xor_b32 v87, v87, v210
    v_or3_b32 v14, v14, v84, v85
    v_or3_b32 v14, v14, v86, v87
    v_mfma_f32_16x16x32_bf16 v[108:111], v[84:87], v[52:55], 0
    s_waitcnt lgkmcnt(0)
    v_xor_b32 v88, v88, v211
    v_xor_b32 v89, v89, v211
    v_xor_b32 v90, v90, v211
    v_xor_b32 v91, v91, v211
    v_or3_b32 v14, v14, v88, v89
    v_or3_b32 v14, v14, v90, v91
    v_mfma_f32_16x16x32_bf16 v[112:115], v[88:91], v[52:55], 0
    v_and_b32 v14, s83, v14
    v_cmp_ne_u32 vcc, 0, v14
    s_nop 0
    s_cmp_eq_u64 vcc, 0
    s_cbranch_scc1 L_h2ok
    s_add_u32 s60, s60, 1
    s_mov_b32 m0, s86
    s_nop 0
    buffer_load_dwordx4 v193, s[48:51], s87 offen offset:0 sc1 lds
    buffer_load_dwordx4 v193, s[48:51], s87 offen offset:1024 sc1 lds
    buffer_load_dwordx4 v193, s[48:51], s87 offen offset:2048 sc1 lds
    buffer_load_dwordx4 v193, s[48:51], s87 offen offset:3072 sc1 lds
    s_cmp_lt_u32 s60, 200000
    s_waitcnt vmcnt(0)
    s_cbranch_scc1 L_h2poll
L_h2ok:
    s_mov_b32 exec_lo, s84
    s_mov_b32 exec_hi, s84
    s_nop 1
    v_cvt_pk_bf16_f32 v120, v100, v101
    v_cvt_pk_bf16_f32 v121, v102, v103
    v_cvt_pk_bf16_f32 v122, v104, v105
    v_cvt_pk_bf16_f32 v123, v106, v107
    ds_write_b128 v205, v[120:123] offset:0
    v_cvt_pk_bf16_f32 v124, v108, v109
    v_cvt_pk_bf16_f32 v125, v110, v111
    v_cvt_pk_bf16_f32 v126, v112, v113
    v_cvt_pk_bf16_f32 v127, v114, v115
    ds_write_b128 v205, v[124:127] offset:1024
    s_mov_b64 exec, -1
    s_bitcmp1_b32 s3, 0
    s_waitcnt lgkmcnt(0)
    s_barrier
    ds_read_b128 v[56:59], v195 offset:0
    ds_read_b128 v[60:63], v195 offset:1024
    ds_read_b128 v[64:67], v195 offset:2048
    ds_read_b128 v[68:71], v195 offset:3072
    s_waitcnt lgkmcnt(3)
    v_mfma_f32_16x16x32_bf16 v[72:75], v[16:19], v[56:59], 0
    s_waitcnt lgkmcnt(2)
    v_mfma_f32_16x16x32_bf16 v[72:75], v[20:23], v[60:63], v[72:75]
    s_waitcnt lgkmcnt(1)
    v_mfma_f32_16x16x32_bf16 v[72:75], v[24:27], v[64:67], v[72:75]
    s_waitcnt lgkmcnt(0)
    v_mfma_f32_16x16x32_bf16 v[72:75], v[28:31], v[68:71], v[72:75]
    s_mov_b32 exec_lo, 0x000f000f
    s_mov_b32 exec_hi, 0x000f000f
    s_cbranch_scc1 L_s4odd
    s_nop 4
    v_cvt_pk_bf16_f32 v186, v72, v73
    v_cvt_pk_bf16_f32 v187, v74, v75
    s_branch L_s4done
L_s4odd:
    s_nop 4
    v_cvt_pk_bf16_f32 v184, v72, v73
    v_cvt_pk_bf16_f32 v185, v74, v75
L_s4done:
    s_cmp_eq_u32 s88, 0
    s_cbranch_scc1 Lls_10
    buffer_store_dwordx4 v[184:187], v198, s[48:51], s77 offen
    s_branch Lle_11
Lls_10:
    buffer_store_dwordx4 v[184:187], v198, s[48:51], s77 offen sc1
Lle_11:
    s_mov_b64 exec, -1
    s_mov_b32 s60, 0
    s_mov_b32 exec_lo, -1
    s_mov_b32 exec_hi, -1
    buffer_load_dwordx4 v[56:59], v228, s[48:51], s76 offen offset:0 sc1
    buffer_load_dwordx4 v[60:63], v228, s[48:51], s76 offen offset:1024 sc1
    buffer_load_dwordx4 v[64:67], v228, s[48:51], s76 offen offset:2048 sc1
    buffer_load_dwordx4 v[68:71], v228, s[48:51], s76 offen offset:3072 sc1
    s_mov_b64 exec, -1
    s_waitcnt vmcnt(5)
    ds_read_b64_tr_b16 v[32:33], v200 offset:0
    ds_read_b64_tr_b16 v[34:35], v200 offset:1024
    ds_read_b64_tr_b16 v[36:37], v201 offset:0
    ds_read_b64_tr_b16 v[38:39], v201 offset:1024
    ds_read_b64_tr_b16 v[40:41], v200 offset:2048
    ds_read_b64_tr_b16 v[42:43], v200 offset:3072
    ds_read_b64_tr_b16 v[44:45], v201 offset:2048
    ds_read_b64_tr_b16 v[46:47], v201 offset:3072
    s_mov_b32 exec_lo, -1
    s_mov_b32 exec_hi, -1
Lmp_12:
    s_waitcnt vmcnt(0)
    v_cmp_ne_u32 s[16:17], v56, v15
    v_cmp_ne_u32 s[18:19], v63, v15
    v_cmp_ne_u32 s[20:21], v64, v15
    v_cmp_ne_u32 s[22:23], v71, v15
    s_or_b64 s[6:7], s[16:17], s[18:19]
    s_or_b64 s[6:7], s[6:7], s[20:21]
    s_or_b64 s[6:7], s[6:7], s[22:23]
    s_cbranch_scc0 Lmok_13
    s_mov_b64 exec, s[16:17]
    s_cbranch_execz Lsk_14
    buffer_load_dwordx4 v[56:59], v228, s[48:51], s76 offen offset:0 sc1
Lsk_14:
    s_mov_b64 exec, s[18:19]
    s_cbranch_execz Lsk_15
    buffer_load_dwordx4 v[60:63], v228, s[48:51], s76 offen offset:1024 sc1
Lsk_15:
    s_mov_b64 exec, s[20:21]
    s_cbranch_execz Lsk_16
    buffer_load_dwordx4 v[64:67], v228, s[48:51], s76 offen offset:2048 sc1
Lsk_16:
    s_mov_b64 exec, s[22:23]
    s_cbranch_execz Lsk_17
    buffer_load_dwordx4 v[68:71], v228, s[48:51], s76 offen offset:3072 sc1
Lsk_17:
    s_mov_b32 exec_lo, -1
    s_mov_b32 exec_hi, -1
    s_add_u32 s60, s60, 1
    s_cmp_lt_u32 s60, 200000
    s_cbranch_scc1 Lmp_12
    s_waitcnt vmcnt(0)
Lmok_13:
    s_mov_b64 exec, -1
    s_waitcnt lgkmcnt(0)
    v_mfma_f32_16x16x32_bf16 v[80:83], v[32:35], v[58:61], 0
    v_mfma_f32_16x16x32_bf16 v[84:87], v[36:39], v[58:61], 0
    v_mfma_f32_16x16x32_bf16 v[80:83], v[40:43], v[66:69], v[80:83]
    v_mfma_f32_16x16x32_bf16 v[84:87], v[44:47], v[66:69], v[84:87]
    s_nop 6
    v_add_f32_dpp v88, v80, v80 row_ror:4 row_mask:0xf bank_mask:0x5
    v_add_f32_dpp v89, v81, v81 row_ror:4 row_mask:0xf bank_mask:0x5
    v_add_f32_dpp v90, v82, v82 row_ror:4 row_mask:0xf bank_mask:0x5
    v_add_f32_dpp v91, v83, v83 row_ror:4 row_mask:0xf bank_mask:0x5
    v_add_f32_dpp v88, v84, v84 row_ror:4 row_mask:0xf bank_mask:0xa
    v_add_f32_dpp v89, v85, v85 row_ror:4 row_mask:0xf bank_mask:0xa
    v_add_f32_dpp v90, v86, v86 row_ror:4 row_mask:0xf bank_mask:0xa
    v_add_f32_dpp v91, v87, v87 row_ror:4 row_mask:0xf bank_mask:0xa
    v_add_f32_dpp v88, v88, v88 row_ror:8 row_mask:0xf bank_mask:0xf
    v_add_f32_dpp v89, v89, v89 row_ror:8 row_mask:0xf bank_mask:0xf
    v_add_f32_dpp v90, v90, v90 row_ror:8 row_mask:0xf bank_mask:0xf
    v_add_f32_dpp v91, v91, v91 row_ror:8 row_mask:0xf bank_mask:0xf
    ds_write_b128 v202, v[88:91]
    s_cmp_eq_u32 s3, 4
    s_waitcnt lgkmcnt(0)
    s_barrier
    s_cbranch_scc1 L_s5fin
    s_cmp_lt_u32 s3, 4
    s_cbranch_scc1 L_red
    s_endpgm
L_s5fin:
    ds_read_b128 v[80:83], v203 offset:0
    ds_read_b128 v[84:87], v203 offset:1024
    ds_read_b128 v[88:91], v203 offset:2048
    ds_read_b128 v[92:95], v203 offset:3072
    s_waitcnt lgkmcnt(0)
    v_pk_add_f32 v[80:81], v[80:81], v[84:85]
    v_pk_add_f32 v[82:83], v[82:83], v[86:87]
    v_pk_add_f32 v[88:89], v[88:89], v[92:93]
    v_pk_add_f32 v[90:91], v[90:91], v[94:95]
    v_pk_add_f32 v[80:81], v[80:81], v[88:89]
    v_pk_add_f32 v[82:83], v[82:83], v[90:91]
    s_nop 0
    v_add_f32_dpp v80, v80, v80 row_ror:8 row_mask:0xf bank_mask:0xf
    v_add_f32_dpp v81, v81, v81 row_ror:8 row_mask:0xf bank_mask:0xf
    v_add_f32_dpp v82, v82, v82 row_ror:8 row_mask:0xf bank_mask:0xf
    v_add_f32_dpp v83, v83, v83 row_ror:8 row_mask:0xf bank_mask:0xf
    s_mov_b32 exec_lo, 0x00ff00ff
    s_mov_b32 exec_hi, 0x00ff00ff
    v_cvt_pk_bf16_f32 v190, v80, v81
    v_cvt_pk_bf16_f32 v191, v82, v83
    buffer_store_dwordx4 v[188:191], v204, s[48:51], s79 offen sc1
L_end:
    s_endpgm
L_g1w03:
    s_barrier
    s_endpgm
L_g1tail:
    v_lshrrev_b32 v9, 2, v1
    v_mul_u32_u24 v6, 3584, v9
    v_lshl_add_u32 v9, v4, 7, v6
    v_lshlrev_b32 v10, 7, v1
    s_mul_i32 s64, s59, 114688
    s_mul_i32 s62, s58, 28672
    s_add_u32 s64, s64, s62
    s_mul_i32 s62, s55, 448
    s_add_u32 s64, s64, s62
    s_and_b32 s61, s59, 7
    s_mul_i32 s63, s61, 28672
    s_mul_i32 s62, s55, 229376
    s_add_u32 s63, s63, s62
    s_mul_i32 s62, s58, 7168
    s_add_u32 s63, s63, s62
    s_barrier
    s_lshl_b32 s61, s52, 13
    s_lshl_b32 s62, s53, 6
    s_add_u32 s61, s61, s62
    s_add_u32 s61, s61, 1310720
    s_mov_b32 s60, 0
    s_mov_b64 exec, 1
L_trig:
    buffer_load_dword v124, v228, s[48:51], s61 offen sc1
    s_add_u32 s60, s60, 1
    s_waitcnt vmcnt(0)
    v_cmp_eq_u32 vcc, v124, v15
    s_cmp_ge_u32 s60, 11
    s_cbranch_scc1 L_trigged
    s_cbranch_vccz L_trig
L_trigged:
    s_mov_b32 exec_lo, -1
    s_mov_b32 exec_hi, 0
    buffer_load_dword v124, v9, s[32:35], s64 offen
    buffer_load_dword v125, v9, s[36:39], s64 offen
    s_mov_b64 exec, -1
    s_cmp_lt_u32 s59, 7
    s_cbranch_scc1 L_ffn
    s_cmp_ge_u32 s59, 8
    s_cbranch_scc1 L_dpf
    s_endpgm
L_dpf:
    s_mov_b32 exec_hi, 0xffffff
    buffer_load_dword v126, v10, s[40:43], s63 offen
    s_endpgm
L_red:
    s_sleep 12
    s_mov_b32 s60, 0
    s_mov_b32 exec_lo, -1
    s_mov_b32 exec_hi, -1
    buffer_load_dwordx4 v[128:131], v228, s[48:51], s68 offen sc1
Lmp_18:
    s_waitcnt vmcnt(0)
    v_cmp_ne_u32 s[12:13], v128, v15
    s_nop 0
    s_or_b64 s[6:7], s[12:13], s[12:13]
    s_cbranch_scc0 Lmok_19
    s_mov_b64 exec, s[12:13]
    s_cbranch_execz Lsk_20
    buffer_load_dwordx4 v[128:131], v228, s[48:51], s68 offen sc1
Lsk_20:
    s_mov_b32 exec_lo, -1
    s_mov_b32 exec_hi, -1
    s_add_u32 s60, s60, 1
    s_cmp_lt_u32 s60, 200000
    s_cbranch_scc1 Lmp_18
    s_waitcnt vmcnt(0)
Lmok_19:
    s_mov_b64 exec, -1
    v_mfma_f32_16x16x32_bf16 v[220:223], v[216:219], v[130:133], 0
    s_nop 7
    v_add_f32_dpp v220, v220, v220 row_ror:8 row_mask:0xf bank_mask:0xf
    v_add_f32_dpp v221, v221, v221 row_ror:8 row_mask:0xf bank_mask:0xf
    v_add_f32_dpp v222, v222, v222 row_ror:8 row_mask:0xf bank_mask:0xf
    v_add_f32_dpp v223, v223, v223 row_ror:8 row_mask:0xf bank_mask:0xf
    v_add_f32 v224, v224, v220
    v_add_f32 v225, v225, v221
    v_add_f32 v226, v226, v222
    v_add_f32 v227, v227, v223
    v_cvt_pk_bf16_f32 v234, v224, v225
    v_cvt_pk_bf16_f32 v235, v226, v227
    v_cndmask_b32 v248, v15, v234, s[70:71]
    v_cndmask_b32 v249, v15, v235, s[70:71]
    v_cndmask_b32 v250, v234, v15, s[70:71]
    v_cndmask_b32 v251, v235, v15, s[70:71]
    s_mov_b64 exec, 0xff
    s_cmp_eq_u32 s88, 0
    s_cbranch_scc1 Lls_21
    buffer_store_dwordx4 v[248:251], v228, s[48:51], s65 offen
    s_branch Lle_22
Lls_21:
    buffer_store_dwordx4 v[248:251], v228, s[48:51], s65 offen sc1
Lle_22:
    s_mov_b64 exec, -1
    s_and_b32 s61, s74, 7
    s_cmp_eq_u32 s61, s55
    s_cbranch_scc1 L_final
    s_endpgm
L_final:
    v_lshlrev_b32 v224, 16, v234
    v_and_b32 v225, 0xffff0000, v234
    v_lshlrev_b32 v226, 16, v235
    v_and_b32 v227, 0xffff0000, v235
    s_lshl_b32 s68, s74, 13
    s_add_u32 s68, s68, 2097152
    s_add_u32 s67, s68, 0x1000
    s_mov_b32 s60, 0
    s_mov_b32 exec_lo, -1
    s_mov_b32 exec_hi, -1
    buffer_load_dwordx4 v[128:131], v228, s[48:51], s68 offen offset:0 sc1
    buffer_load_dwordx4 v[132:135], v228, s[48:51], s68 offen offset:1024 sc1
    buffer_load_dwordx4 v[136:139], v228, s[48:51], s68 offen offset:2048 sc1
    buffer_load_dwordx4 v[140:143], v228, s[48:51], s68 offen offset:3072 sc1
    buffer_load_dwordx4 v[144:147], v228, s[48:51], s67 offen offset:0 sc1
    buffer_load_dwordx4 v[148:151], v228, s[48:51], s67 offen offset:1024 sc1
    buffer_load_dwordx4 v[152:155], v228, s[48:51], s67 offen offset:2048 sc1
Lmp_23:
    s_waitcnt vmcnt(0)
    v_cmp_ne_u32 s[12:13], v128, v15
    v_cmp_ne_u32 s[14:15], v135, v15
    v_cmp_ne_u32 s[16:17], v136, v15
    v_cmp_ne_u32 s[18:19], v143, v15
    v_cmp_ne_u32 s[20:21], v144, v15
    v_cmp_ne_u32 s[22:23], v151, v15
    v_cmp_ne_u32 s[24:25], v152, v15
    s_or_b64 s[6:7], s[12:13], s[14:15]
    s_or_b64 s[6:7], s[6:7], s[16:17]
    s_or_b64 s[6:7], s[6:7], s[18:19]
    s_or_b64 s[6:7], s[6:7], s[20:21]
    s_or_b64 s[6:7], s[6:7], s[22:23]
    s_or_b64 s[6:7], s[6:7], s[24:25]
    s_cbranch_scc0 Lmok_24
    s_mov_b64 exec, s[12:13]
    s_cbranch_execz Lsk_25
    buffer_load_dwordx4 v[128:131], v228, s[48:51], s68 offen offset:0 sc1
Lsk_25:
    s_mov_b64 exec, s[14:15]
    s_cbranch_execz Lsk_26
    buffer_load_dwordx4 v[132:135], v228, s[48:51], s68 offen offset:1024 sc1
Lsk_26:
    s_mov_b64 exec, s[16:17]
    s_cbranch_execz Lsk_27
    buffer_load_dwordx4 v[136:139], v228, s[48:51], s68 offen offset:2048 sc1
Lsk_27:
    s_mov_b64 exec, s[18:19]
    s_cbranch_execz Lsk_28
    buffer_load_dwordx4 v[140:143], v228, s[48:51], s68 offen offset:3072 sc1
Lsk_28:
    s_mov_b64 exec, s[20:21]
    s_cbranch_execz Lsk_29
    buffer_load_dwordx4 v[144:147], v228, s[48:51], s67 offen offset:0 sc1
Lsk_29:
    s_mov_b64 exec, s[22:23]
    s_cbranch_execz Lsk_30
    buffer_load_dwordx4 v[148:151], v228, s[48:51], s67 offen offset:1024 sc1
Lsk_30:
    s_mov_b64 exec, s[24:25]
    s_cbranch_execz Lsk_31
    buffer_load_dwordx4 v[152:155], v228, s[48:51], s67 offen offset:2048 sc1
Lsk_31:
    s_mov_b32 exec_lo, -1
    s_mov_b32 exec_hi, -1
    s_add_u32 s60, s60, 1
    s_cmp_lt_u32 s60, 200000
    s_cbranch_scc1 Lmp_23
    s_waitcnt vmcnt(0)
Lmok_24:
    s_mov_b64 exec, -1
    v_mfma_f32_16x16x32_bf16 v[220:223], v[216:219], v[130:133], 0
    v_mfma_f32_16x16x32_bf16 v[220:223], v[216:219], v[138:141], v[220:223]
    v_mfma_f32_16x16x32_bf16 v[220:223], v[216:219], v[146:149], v[220:223]
    v_mfma_f32_16x16x32_bf16 v[220:223], v[216:219], v[154:157], v[220:223]
    s_nop 7
    v_add_f32_dpp v220, v220, v220 row_ror:8 row_mask:0xf bank_mask:0xf
    v_add_f32_dpp v221, v221, v221 row_ror:8 row_mask:0xf bank_mask:0xf
    v_add_f32_dpp v222, v222, v222 row_ror:8 row_mask:0xf bank_mask:0xf
    v_add_f32_dpp v223, v223, v223 row_ror:8 row_mask:0xf bank_mask:0xf
    v_add_f32 v224, v224, v220
    v_add_f32 v225, v225, v221
    v_add_f32 v226, v226, v222
    v_add_f32 v227, v227, v223
    v_cvt_pk_bf16_f32 v234, v224, v225
    v_cvt_pk_bf16_f32 v235, v226, v227
    s_mov_b64 exec, 0xff
    buffer_store_dwordx2 v[234:235], v243, s[44:47], s75 offen
    s_cmp_eq_u32 s74, 0
    s_cbranch_scc1 L_epoch
    s_endpgm
L_epoch:
    s_mov_b64 exec, 1
    buffer_store_dword v15, v228, s[48:51], 0 offen sc1
    s_endpgm
L_ffn:
    s_mul_i32 s74, s55, 7
    s_add_u32 s74, s74, s59
    v_and_b32 v7, 1, v2
    v_lshlrev_b32 v8, 1, v7
    v_xor_b32 v8, v8, v4
    v_lshl_add_u32 v6, v8, 4, v6
    v_lshl_add_u32 v8, v2, 2, v5
    v_lshlrev_b32 v104, 6, v8
    v_lshl_add_u32 v104, v4, 3, v104
    s_lshl_b32 s64, s58, 13
    v_add_u32 v104, s64, v104
    v_lshl_add_u32 v104, v7, 5, v104
    v_xor_b32 v105, 32, v104
    v_mul_u32_u24 v106, 1056, v8
    v_lshl_add_u32 v106, v4, 3, v106
    s_lshl_b32 s61, s58, 8
    s_add_u32 s61, s61, 65536
    v_add_u32 v106, s61, v106
    v_lshlrev_b32 v107, 7, v2
    v_lshl_add_u32 v107, v4, 4, v107
    v_lshrrev_b32 v7, 1, v5
    v_lshl_add_u32 v7, v7, 2, v2
    v_lshlrev_b32 v7, 13, v7
    v_and_b32 v8, 7, v1
    v_lshl_add_u32 v108, v8, 4, v7
    v_lshlrev_b32 v109, 5, v4
    v_add_u32 v109, 110592, v109
    s_lshl_b32 s61, s58, 2
    v_lshl_add_u32 v110, v2, 4, v109
    v_add_u32 v110, s61, v110
    v_add_u32 v111, 102400, v228
    s_lshl_b32 s61, s58, 10
    v_add_u32 v14, s61, v111
    v_cmp_gt_u32 vcc, 2, v5
    v_mov_b32 v12, 0xff800000
    s_nop 0
    v_cndmask_b32 v12, v12, 0, vcc
    s_mul_i32 s68, s58, 8448
    v_mov_b32 v248, s82
    v_mov_b32 v249, s82
    v_mov_b32 v250, s82
    v_mov_b32 v251, s82
    v_mov_b32 v232, s4
    v_mov_b32 v238, s4
    v_mov_b32 v233, s4
    v_mov_b32 v239, s4
    v_mov_b32 v236, s4
    v_mov_b32 v242, s4
    v_mov_b32 v237, s4
    v_mov_b32 v243, s4
    v_mov_b32 v18, s82
    v_mov_b32 v19, s82
    v_mov_b32 v20, s82
    v_mov_b32 v21, s82
    v_mov_b32 v26, s82
    v_mov_b32 v27, s82
    v_mov_b32 v28, s82
    v_mov_b32 v29, s82
    v_mov_b32 v34, s82
    v_mov_b32 v35, s82
    v_mov_b32 v36, s82
    v_mov_b32 v37, s82
    v_mov_b32 v42, s82
    v_mov_b32 v43, s82
    v_mov_b32 v44, s82
    v_mov_b32 v45, s82
    s_lshl_b32 s65, s55, 13
    s_lshl_b32 s62, s58, 11
    s_add_u32 s65, s65, s62
    s_add_u32 s65, s65, 1179648
    s_lshl_b32 s66, s58, 17
    s_lshl_b32 s62, s74, 7
    s_add_u32 s66, s66, s62
    s_add_u32 s66, s66, 2097152
    s_add_u32 s67, s66, 0x10000
    s_mul_i32 s61, s58, 458752
    s_lshl_b32 s62, s74, 6
    s_add_u32 s61, s61, s62
    s_lshl_b32 s63, s74, 15
    s_lshl_b32 s62, s58, 13
    s_add_u32 s63, s63, s62
    s_waitcnt vmcnt(0)
    s_add_u32 m0, s64, 0
    s_nop 0
    buffer_load_dwordx4 v6, s[32:35], s61 offen lds
    s_add_u32 m0, s64, 32768
    s_nop 0
    buffer_load_dwordx4 v6, s[36:39], s61 offen lds
    s_add_u32 s61, s61, 57344
    s_add_u32 m0, s64, 1024
    s_nop 0
    buffer_load_dwordx4 v6, s[32:35], s61 offen lds
    s_add_u32 m0, s64, 33792
    s_nop 0
    buffer_load_dwordx4 v6, s[36:39], s61 offen lds
    s_add_u32 s61, s61, 57344
    s_add_u32 m0, s64, 2048
    s_nop 0
    buffer_load_dwordx4 v6, s[32:35], s61 offen lds
    s_add_u32 m0, s64, 34816
    s_nop 0
    buffer_load_dwordx4 v6, s[36:39], s61 offen lds
    s_add_u32 s61, s61, 57344
    s_add_u32 m0, s64, 3072
    s_nop 0
    buffer_load_dwordx4 v6, s[32:35], s61 offen lds
    s_add_u32 m0, s64, 35840
    s_nop 0
    buffer_load_dwordx4 v6, s[36:39], s61 offen lds
    s_add_u32 s61, s61, 57344
    s_add_u32 m0, s64, 4096
    s_nop 0
    buffer_load_dwordx4 v6, s[32:35], s61 offen lds
    s_add_u32 m0, s64, 36864
    s_nop 0
    buffer_load_dwordx4 v6, s[36:39], s61 offen lds
    s_add_u32 s61, s61, 57344
    s_add_u32 m0, s64, 5120
    s_nop 0
    buffer_load_dwordx4 v6, s[32:35], s61 offen lds
    s_add_u32 m0, s64, 37888
    s_nop 0
    buffer_load_dwordx4 v6, s[36:39], s61 offen lds
    s_add_u32 s61, s61, 57344
    s_add_u32 m0, s64, 6144
    s_nop 0
    buffer_load_dwordx4 v6, s[32:35], s61 offen lds
    s_add_u32 m0, s64, 38912
    s_nop 0
    buffer_load_dwordx4 v6, s[36:39], s61 offen lds
    s_add_u32 s61, s61, 57344
    s_add_u32 m0, s64, 7168
    s_nop 0
    buffer_load_dwordx4 v6, s[32:35], s61 offen lds
    s_add_u32 m0, s64, 39936
    s_nop 0
    buffer_load_dwordx4 v6, s[36:39], s61 offen lds
    s_add_u32 m0, s68, 65536
    s_nop 0
    buffer_load_dwordx4 v228, s[40:43], s63 offen lds
    s_add_u32 s63, s63, 1024
    s_add_u32 m0, s68, 66592
    s_nop 0
    buffer_load_dwordx4 v228, s[40:43], s63 offen lds
    s_add_u32 s63, s63, 1024
    s_add_u32 m0, s68, 67648
    s_nop 0
    buffer_load_dwordx4 v228, s[40:43], s63 offen lds
    s_add_u32 s63, s63, 1024
    s_add_u32 m0, s68, 68704
    s_nop 0
    buffer_load_dwordx4 v228, s[40:43], s63 offen lds
    s_add_u32 s63, s63, 1024
    s_add_u32 m0, s68, 69760
    s_nop 0
    buffer_load_dwordx4 v228, s[40:43], s63 offen lds
    s_add_u32 s63, s63, 1024
    s_add_u32 m0, s68, 70816
    s_nop 0
    buffer_load_dwordx4 v228, s[40:43], s63 offen lds
    s_add_u32 s63, s63, 1024
    s_add_u32 m0, s68, 71872
    s_nop 0
    buffer_load_dwordx4 v228, s[40:43], s63 offen lds
    s_add_u32 s63, s63, 1024
    s_add_u32 m0, s68, 72928
    s_nop 0
    buffer_load_dwordx4 v228, s[40:43], s63 offen lds
    s_mov_b32 s60, 0
    s_mov_b32 exec_lo, 0x000f000f
    s_mov_b32 exec_hi, 0x000f000f
    buffer_load_dwordx4 v[16:19], v107, s[48:51], s65 offen offset:0 sc1
    buffer_load_dwordx4 v[20:23], v107, s[48:51], s65 offen offset:64 sc1
    buffer_load_dwordx4 v[24:27], v107, s[48:51], s65 offen offset:512 sc1
    buffer_load_dwordx4 v[28:31], v107, s[48:51], s65 offen offset:576 sc1
    buffer_load_dwordx4 v[32:35], v107, s[48:51], s65 offen offset:1024 sc1
    buffer_load_dwordx4 v[36:39], v107, s[48:51], s65 offen offset:1088 sc1
    buffer_load_dwordx4 v[40:43], v107, s[48:51], s65 offen offset:1536 sc1
    buffer_load_dwordx4 v[44:47], v107, s[48:51], s65 offen offset:1600 sc1
    s_mov_b64 exec, -1
    s_waitcnt vmcnt(28)
    ds_read_b64_tr_b16 v[112:113], v104 offset:0
    ds_read_b64_tr_b16 v[114:115], v104 offset:1024
    ds_read_b64_tr_b16 v[128:129], v105 offset:0
    ds_read_b64_tr_b16 v[130:131], v105 offset:1024
    ds_read_b64_tr_b16 v[144:145], v104 offset:32768
    ds_read_b64_tr_b16 v[146:147], v104 offset:33792
    ds_read_b64_tr_b16 v[160:161], v105 offset:32768
    ds_read_b64_tr_b16 v[162:163], v105 offset:33792
    s_waitcnt vmcnt(24)
    ds_read_b64_tr_b16 v[116:117], v104 offset:2048
    ds_read_b64_tr_b16 v[118:119], v104 offset:3072
    ds_read_b64_tr_b16 v[132:133], v105 offset:2048
    ds_read_b64_tr_b16 v[134:135], v105 offset:3072
    ds_read_b64_tr_b16 v[148:149], v104 offset:34816
    ds_read_b64_tr_b16 v[150:151], v104 offset:35840
    ds_read_b64_tr_b16 v[164:165], v105 offset:34816
    ds_read_b64_tr_b16 v[166:167], v105 offset:35840
    s_waitcnt lgkmcnt(8)
    v_mfma_f32_16x16x32_bf16 v[208:211], v[112:115], v[248:251], 0
    v_mfma_f32_16x16x32_bf16 v[212:215], v[128:131], v[248:251], 0
    v_mfma_f32_16x16x32_bf16 v[216:219], v[144:147], v[248:251], 0
    v_mfma_f32_16x16x32_bf16 v[220:223], v[160:163], v[248:251], 0
    s_waitcnt vmcnt(20)
    ds_read_b64_tr_b16 v[120:121], v104 offset:4096
    ds_read_b64_tr_b16 v[122:123], v104 offset:5120
    ds_read_b64_tr_b16 v[136:137], v105 offset:4096
    ds_read_b64_tr_b16 v[138:139], v105 offset:5120
    ds_read_b64_tr_b16 v[152:153], v104 offset:36864
    ds_read_b64_tr_b16 v[154:155], v104 offset:37888
    ds_read_b64_tr_b16 v[168:169], v105 offset:36864
    ds_read_b64_tr_b16 v[170:171], v105 offset:37888
    s_waitcnt lgkmcnt(8)
    v_mfma_f32_16x16x32_bf16 v[208:211], v[116:119], v[248:251], v[208:211]
    v_mfma_f32_16x16x32_bf16 v[212:215], v[132:135], v[248:251], v[212:215]
    v_mfma_f32_16x16x32_bf16 v[216:219], v[148:151], v[248:251], v[216:219]
    v_mfma_f32_16x16x32_bf16 v[220:223], v[164:167], v[248:251], v[220:223]
    s_waitcnt vmcnt(16)
    ds_read_b64_tr_b16 v[124:125], v104 offset:6144
    ds_read_b64_tr_b16 v[126:127], v104 offset:7168
    ds_read_b64_tr_b16 v[140:141], v105 offset:6144
    ds_read_b64_tr_b16 v[142:143], v105 offset:7168
    ds_read_b64_tr_b16 v[156:157], v104 offset:38912
    ds_read_b64_tr_b16 v[158:159], v104 offset:39936
    ds_read_b64_tr_b16 v[172:173], v105 offset:38912
    ds_read_b64_tr_b16 v[174:175], v105 offset:39936
    s_waitcnt lgkmcnt(8)
    v_mfma_f32_16x16x32_bf16 v[208:211], v[120:123], v[248:251], v[208:211]
    v_mfma_f32_16x16x32_bf16 v[212:215], v[136:139], v[248:251], v[212:215]
    v_mfma_f32_16x16x32_bf16 v[216:219], v[152:155], v[248:251], v[216:219]
    v_mfma_f32_16x16x32_bf16 v[220:223], v[168:171], v[248:251], v[220:223]
    s_waitcnt lgkmcnt(0)
    v_mfma_f32_16x16x32_bf16 v[208:211], v[124:127], v[248:251], v[208:211]
    v_mfma_f32_16x16x32_bf16 v[212:215], v[140:143], v[248:251], v[212:215]
    v_mfma_f32_16x16x32_bf16 v[216:219], v[156:159], v[248:251], v[216:219]
    v_mfma_f32_16x16x32_bf16 v[220:223], v[172:175], v[248:251], v[220:223]
    s_nop 5
    v_mov_b32_dpp v208, v212 row_shr:4 row_mask:0xf bank_mask:0x2
    v_mov_b32_dpp v209, v213 row_shr:4 row_mask:0xf bank_mask:0x2
    v_mov_b32_dpp v210, v214 row_shr:4 row_mask:0xf bank_mask:0x2
    v_mov_b32_dpp v211, v215 row_shr:4 row_mask:0xf bank_mask:0x2
    v_mov_b32_dpp v208, v216 row_shr:8 row_mask:0xf bank_mask:0x4
    v_mov_b32_dpp v209, v217 row_shr:8 row_mask:0xf bank_mask:0x4
    v_mov_b32_dpp v210, v218 row_shr:8 row_mask:0xf bank_mask:0x4
    v_mov_b32_dpp v211, v219 row_shr:8 row_mask:0xf bank_mask:0x4
    v_mov_b32_dpp v208, v220 row_shr:12 row_mask:0xf bank_mask:0x8
    v_mov_b32_dpp v209, v221 row_shr:12 row_mask:0xf bank_mask:0x8
    v_mov_b32_dpp v210, v222 row_shr:12 row_mask:0xf bank_mask:0x8
    v_mov_b32_dpp v211, v223 row_shr:12 row_mask:0xf bank_mask:0x8
    ds_write_b128 v14, v[208:211]
    s_waitcnt vmcnt(8) lgkmcnt(0)
    s_barrier
    ds_read_b128 v[80:83], v111 offset:0
    ds_read_b128 v[84:87], v111 offset:1024
    ds_read_b128 v[88:91], v111 offset:2048
    ds_read_b128 v[92:95], v111 offset:3072
    ds_read_b64_tr_b16 v[176:177], v106 offset:0
    ds_read_b64_tr_b16 v[178:179], v106 offset:16896
    ds_read_b64_tr_b16 v[180:181], v106 offset:32
    ds_read_b64_tr_b16 v[182:183], v106 offset:16928
    ds_read_b64_tr_b16 v[184:185], v106 offset:64
    ds_read_b64_tr_b16 v[186:187], v106 offset:16960
    ds_read_b64_tr_b16 v[188:189], v106 offset:96
    ds_read_b64_tr_b16 v[190:191], v106 offset:16992
    ds_read_b64_tr_b16 v[192:193], v106 offset:128
    ds_read_b64_tr_b16 v[194:195], v106 offset:17024
    ds_read_b64_tr_b16 v[196:197], v106 offset:160
    ds_read_b64_tr_b16 v[198:199], v106 offset:17056
    ds_read_b64_tr_b16 v[200:201], v106 offset:192
    ds_read_b64_tr_b16 v[202:203], v106 offset:17088
    ds_read_b64_tr_b16 v[204:205], v106 offset:224
    ds_read_b64_tr_b16 v[206:207], v106 offset:17120
    s_waitcnt lgkmcnt(15)
    v_pk_add_f32 v[80:81], v[80:81], v[84:85]
    v_pk_add_f32 v[88:89], v[88:89], v[92:93]
    v_pk_add_f32 v[96:97], v[80:81], v[88:89]
    v_pk_add_f32 v[82:83], v[82:83], v[86:87]
    v_pk_add_f32 v[90:91], v[90:91], v[94:95]
    v_pk_add_f32 v[98:99], v[82:83], v[90:91]
    s_mov_b32 exec_lo, 0x000f000f
    s_mov_b32 exec_hi, 0x000f000f
Lmp_32:
    s_waitcnt vmcnt(0)
    v_bitop3_b32 v100, v16, v23, v15 bitop3:0x7e
    v_bitop3_b32 v101, v24, v31, v15 bitop3:0x7e
    v_bitop3_b32 v102, v32, v39, v15 bitop3:0x7e
    v_bitop3_b32 v103, v40, v47, v15 bitop3:0x7e
    v_cmp_ne_u32 s[16:17], 0, v100
    v_cmp_ne_u32 s[18:19], 0, v101
    v_cmp_ne_u32 s[20:21], 0, v102
    v_cmp_ne_u32 s[22:23], 0, v103
    s_or_b64 s[6:7], s[16:17], s[18:19]
    s_or_b64 s[6:7], s[6:7], s[20:21]
    s_or_b64 s[6:7], s[6:7], s[22:23]
    s_cbranch_scc0 Lmok_33
    s_mov_b64 exec, s[16:17]
    s_cbranch_execz Lsk_34
    buffer_load_dwordx4 v[16:19], v107, s[48:51], s65 offen offset:0 sc1
    buffer_load_dwordx4 v[20:23], v107, s[48:51], s65 offen offset:64 sc1
Lsk_34:
    s_mov_b64 exec, s[18:19]
    s_cbranch_execz Lsk_35
    buffer_load_dwordx4 v[24:27], v107, s[48:51], s65 offen offset:512 sc1
    buffer_load_dwordx4 v[28:31], v107, s[48:51], s65 offen offset:576 sc1
Lsk_35:
    s_mov_b64 exec, s[20:21]
    s_cbranch_execz Lsk_36
    buffer_load_dwordx4 v[32:35], v107, s[48:51], s65 offen offset:1024 sc1
    buffer_load_dwordx4 v[36:39], v107, s[48:51], s65 offen offset:1088 sc1
Lsk_36:
    s_mov_b64 exec, s[22:23]
    s_cbranch_execz Lsk_37
    buffer_load_dwordx4 v[40:43], v107, s[48:51], s65 offen offset:1536 sc1
    buffer_load_dwordx4 v[44:47], v107, s[48:51], s65 offen offset:1600 sc1
Lsk_37:
    s_mov_b32 exec_lo, 0x000f000f
    s_mov_b32 exec_hi, 0x000f000f
    s_add_u32 s60, s60, 1
    s_cmp_lt_u32 s60, 200000
    s_cbranch_scc1 Lmp_32
    s_waitcnt vmcnt(0)
Lmok_33:
    s_mov_b64 exec, -1
    v_mfma_f32_16x16x32_bf16 v[224:227], v[18:21], v[18:21], 0
    v_mfma_f32_16x16x32_bf16 v[224:227], v[26:29], v[26:29], v[224:227]
    v_mfma_f32_16x16x32_bf16 v[224:227], v[34:37], v[34:37], v[224:227]
    v_mfma_f32_16x16x32_bf16 v[224:227], v[42:45], v[42:45], v[224:227]
    v_mfma_f32_16x16x32_bf16 v[208:211], v[112:115], v[18:21], 0
    v_mfma_f32_16x16x32_bf16 v[212:215], v[128:131], v[18:21], 0
    v_mfma_f32_16x16x32_bf16 v[216:219], v[144:147], v[18:21], 0
    v_mfma_f32_16x16x32_bf16 v[220:223], v[160:163], v[18:21], 0
    v_mfma_f32_16x16x32_bf16 v[208:211], v[116:119], v[26:29], v[208:211]
    v_mfma_f32_16x16x32_bf16 v[212:215], v[132:135], v[26:29], v[212:215]
    v_mfma_f32_16x16x32_bf16 v[216:219], v[148:151], v[26:29], v[216:219]
    v_mfma_f32_16x16x32_bf16 v[220:223], v[164:167], v[26:29], v[220:223]
    v_mfma_f32_16x16x32_bf16 v[208:211], v[120:123], v[34:37], v[208:211]
    v_mfma_f32_16x16x32_bf16 v[212:215], v[136:139], v[34:37], v[212:215]
    v_mfma_f32_16x16x32_bf16 v[216:219], v[152:155], v[34:37], v[216:219]
    v_mfma_f32_16x16x32_bf16 v[220:223], v[168:171], v[34:37], v[220:223]
    v_mfma_f32_16x16x32_bf16 v[208:211], v[124:127], v[42:45], v[208:211]
    v_mfma_f32_16x16x32_bf16 v[212:215], v[140:143], v[42:45], v[212:215]
    v_mfma_f32_16x16x32_bf16 v[216:219], v[156:159], v[42:45], v[216:219]
    v_mfma_f32_16x16x32_bf16 v[220:223], v[172:175], v[42:45], v[220:223]
    s_mov_b64 exec, 2
    v_mov_b32 v224, v225
    s_mov_b64 exec, 4
    v_mov_b32 v224, v226
    s_mov_b64 exec, 8
    v_mov_b32 v224, v227
    s_mov_b64 exec, 0x000f000f
    ds_write_b32 v110, v224
    s_mov_b64 exec, -1
    v_mov_b32_dpp v208, v212 row_shr:4 row_mask:0xf bank_mask:0x2
    v_mov_b32_dpp v209, v213 row_shr:4 row_mask:0xf bank_mask:0x2
    v_mov_b32_dpp v210, v214 row_shr:4 row_mask:0xf bank_mask:0x2
    v_mov_b32_dpp v211, v215 row_shr:4 row_mask:0xf bank_mask:0x2
    v_mov_b32_dpp v208, v216 row_shr:8 row_mask:0xf bank_mask:0x4
    v_mov_b32_dpp v209, v217 row_shr:8 row_mask:0xf bank_mask:0x4
    v_mov_b32_dpp v210, v218 row_shr:8 row_mask:0xf bank_mask:0x4
    v_mov_b32_dpp v211, v219 row_shr:8 row_mask:0xf bank_mask:0x4
    v_mov_b32_dpp v208, v220 row_shr:12 row_mask:0xf bank_mask:0x8
    v_mov_b32_dpp v209, v221 row_shr:12 row_mask:0xf bank_mask:0x8
    v_mov_b32_dpp v210, v222 row_shr:12 row_mask:0xf bank_mask:0x8
    v_mov_b32_dpp v211, v223 row_shr:12 row_mask:0xf bank_mask:0x8
    ds_write_b128 v14, v[208:211] offset:4096
    s_waitcnt lgkmcnt(0)
    s_barrier
    ds_read_b128 v[16:19], v109
    ds_read_b128 v[20:23], v109 offset:16
    ds_read_b128 v[80:83], v111 offset:4096
    ds_read_b128 v[84:87], v111 offset:5120
    ds_read_b128 v[88:91], v111 offset:6144
    ds_read_b128 v[92:95], v111 offset:7168
    s_waitcnt lgkmcnt(4)
    v_pk_add_f32 v[16:17], v[16:17], v[18:19]
    v_pk_add_f32 v[20:21], v[20:21], v[22:23]
    v_add_f32 v17, v16, v17
    v_add_f32 v16, v20, v21
    v_mul_f32 v16, 0xbb000000, v16
    v_mul_f32 v18, 0x3b000000, v17
    v_fma_f32 v18, -v16, v16, v18
    v_max_f32 v18, 0, v18
    v_add_f32 v18, 0x3727c5ac, v18
    v_rsq_f32 v18, v18
    s_waitcnt lgkmcnt(0)
    v_pk_add_f32 v[80:81], v[80:81], v[84:85]
    v_pk_add_f32 v[88:89], v[88:89], v[92:93]
    v_pk_add_f32 v[80:81], v[80:81], v[88:89]
    v_pk_add_f32 v[82:83], v[82:83], v[86:87]
    v_pk_add_f32 v[90:91], v[90:91], v[94:95]
    v_pk_add_f32 v[82:83], v[82:83], v[90:91]
    v_fmac_f32 v80, v16, v96
    v_fmac_f32 v81, v16, v97
    v_fmac_f32 v82, v16, v98
    v_fmac_f32 v83, v16, v99
    v_mul_f32 v80, v18, v80
    v_mul_f32 v81, v18, v81
    v_mul_f32 v82, v18, v82
    v_mul_f32 v83, v18, v83
    v_max_f32 v80, v12, v80
    v_max_f32 v81, v12, v81
    v_max_f32 v82, v12, v82
    v_max_f32 v83, v12, v83
    v_mul_f32_dpp v84, v80, v80 row_ror:8 row_mask:0xf bank_mask:0xf
    v_mul_f32_dpp v85, v81, v81 row_ror:8 row_mask:0xf bank_mask:0xf
    v_mul_f32_dpp v86, v82, v82 row_ror:8 row_mask:0xf bank_mask:0xf
    v_mul_f32_dpp v87, v83, v83 row_ror:8 row_mask:0xf bank_mask:0xf
    v_cvt_pk_bf16_f32 v88, v84, v85
    v_cvt_pk_bf16_f32 v89, v86, v87
    v_cvt_pk_bf16_f32 v92, v84, v85
    v_cvt_pk_bf16_f32 v93, v86, v87
    v_cvt_pk_bf16_f32 v94, v84, v85
    v_cvt_pk_bf16_f32 v95, v86, v87
    v_mov_b32_dpp v92, v88 row_ror:4 row_mask:0xf bank_mask:0xa
    v_mov_b32_dpp v93, v89 row_ror:4 row_mask:0xf bank_mask:0xa
    v_mov_b32_dpp v94, v88 row_ror:4 row_mask:0xf bank_mask:0x5
    v_mov_b32_dpp v95, v89 row_ror:4 row_mask:0xf bank_mask:0x5
    s_nop 1
    v_mfma_f32_16x16x32_bf16 v[48:51], v[176:179], v[92:95], 0
    v_mfma_f32_16x16x32_bf16 v[64:67], v[192:195], v[92:95], 0
    v_mfma_f32_16x16x32_bf16 v[52:55], v[180:183], v[92:95], 0
    v_mfma_f32_16x16x32_bf16 v[68:71], v[196:199], v[92:95], 0
    v_mfma_f32_16x16x32_bf16 v[56:59], v[184:187], v[92:95], 0
    v_mfma_f32_16x16x32_bf16 v[72:75], v[200:203], v[92:95], 0
    v_mfma_f32_16x16x32_bf16 v[60:63], v[188:191], v[92:95], 0
    v_mfma_f32_16x16x32_bf16 v[76:79], v[204:207], v[92:95], 0
    s_bitcmp1_b32 s74, 3
    v_cvt_pk_bf16_f32 v234, v48, v49
    v_cvt_pk_bf16_f32 v235, v50, v51
    v_cvt_pk_bf16_f32 v240, v64, v65
    v_cvt_pk_bf16_f32 v241, v66, v67
    s_mov_b32 exec_lo, 0x00f000f0
    s_mov_b32 exec_hi, 0x00f000f0
    v_cvt_pk_bf16_f32 v234, v52, v53
    v_cvt_pk_bf16_f32 v235, v54, v55
    v_cvt_pk_bf16_f32 v240, v68, v69
    v_cvt_pk_bf16_f32 v241, v70, v71
    s_mov_b32 exec_lo, 0x0f000f00
    s_mov_b32 exec_hi, 0x0f000f00
    v_cvt_pk_bf16_f32 v234, v56, v57
    v_cvt_pk_bf16_f32 v235, v58, v59
    v_cvt_pk_bf16_f32 v240, v72, v73
    v_cvt_pk_bf16_f32 v241, v74, v75
    s_mov_b32 exec_lo, 0xf000f000
    s_mov_b32 exec_hi, 0xf000f000
    v_cvt_pk_bf16_f32 v234, v60, v61
    v_cvt_pk_bf16_f32 v235, v62, v63
    v_cvt_pk_bf16_f32 v240, v76, v77
    v_cvt_pk_bf16_f32 v241, v78, v79
    s_mov_b64 exec, -1
    s_cbranch_scc1 L_s7odd
    buffer_store_dwordx4 v[232:235], v108, s[48:51], s66 offen sc1
    buffer_store_dwordx4 v[238:241], v108, s[48:51], s67 offen sc1
    s_endpgm
L_s7odd:
    buffer_store_dwordx4 v[234:237], v108, s[48:51], s66 offen sc1
    buffer_store_dwordx4 v[240:243], v108, s[48:51], s67 offen sc1
    s_endpgm
L_g0front:
    s_cmp_lt_u32 s3, 4
    s_cbranch_scc1 L_g0s
    v_and_b32 v9, 1, v1
    v_lshlrev_b32 v9, 7, v9
    v_lshrrev_b32 v8, 1, v1
    v_lshl_add_u32 v9, v8, 13, v9
    v_lshlrev_b32 v8, 7, v4
    s_lshl_b32 s61, s53, 20
    s_lshl_b32 s62, s58, 18
    s_add_u32 s61, s61, s62
    s_lshl_b32 s62, s52, 8
    s_add_u32 s61, s61, s62
    s_lshl_b32 s63, s52, 13
    s_lshl_b32 s62, s53, 11
    s_add_u32 s63, s63, s62
    s_lshl_b32 s62, s58, 9
    s_add_u32 s63, s63, s62
    s_add_u32 s63, s63, 262144
    buffer_load_dword v46, v8, s[48:51], s63 offen sc1
    s_cmp_lt_u32 s58, 0
    s_cbranch_scc1 L_nouk
    buffer_load_dword v47, v9, s[20:23], s61 offen
L_nouk:
    s_barrier
    s_waitcnt lgkmcnt(0)
    s_add_u32 s4, s5, 0x9e3779b9
    v_mov_b32 v15, s4
    s_branch L_qgather
L_g0s:
    s_barrier
L_stream:
    s_lshl_b32 s84, s57, 17
    s_lshl_b32 s62, s58, 15
    s_add_u32 s84, s84, s62
    s_movk_i32 s85, 1024
    s_mul_i32 m0, s58, 33792
    s_mov_b32 s86, 0
L_sl0:
    buffer_load_dwordx4 v228, s[12:15], s84 offen lds
    s_add_u32 s84, s84, s85
    s_add_u32 m0, m0, 1056
    s_add_u32 s86, s86, 1
    s_cmp_lt_u32 s86, 6
    s_cbranch_scc1 L_sl0
    s_lshl2_add_u32 s74, s59, s3
    s_lshl_b32 s75, s59, 6
    s_lshl_b32 s62, s3, 3
    s_add_u32 s75, s75, s62
    s_lshl_b32 s68, s74, 10
    s_add_u32 s68, s68, 1114112
    s_lshl_b32 s65, s55, 13
    s_lshl_b32 s62, s74, 7
    s_add_u32 s65, s65, s62
    s_add_u32 s65, s65, 1179648
    s_cmp_lg_u32 s56, 0
    s_cbranch_scc1 L_nrp
    buffer_load_dwordx2 v[234:235], v243, s[8:11], s75 offen
    s_mov_b64 exec, 1
    buffer_load_dword v236, v228, s[48:51], s65 offen sc1
    s_mov_b64 exec, -1
L_nrp:
    v_lshl_add_u32 v229, v2, 2, v5
    v_mul_u32_u24 v229, 1056, v229
    v_lshl_add_u32 v229, v4, 3, v229
    s_lshl_b32 s61, s3, 7
    v_add_u32 v229, s61, v229
    v_add_u32 v230, 67584, v229
    v_add_u32 v231, 135168, v228
    s_lshl_b32 s61, s3, 11
    s_add_u32 s61, s61, 139264
    v_add_u32 v233, s61, v228
    v_lshl_add_u32 v9, v3, 7, s61
    v_lshlrev_b32 v6, 1, v2
    v_xor_b32 v6, v6, v3
    v_and_b32 v6, 7, v6
    v_lshl_add_u32 v252, v6, 4, v9
    v_xor_b32 v253, 16, v252
    v_lshrrev_b32 v6, 3, v1
    v_xor_b32 v7, v6, v1
    v_and_b32 v7, 7, v7
    v_lshlrev_b32 v7, 4, v7
    v_lshl_add_u32 v232, v6, 17, v7
    s_lshl_b32 s72, s56, 21
    s_lshl_b32 s62, s3, 14
    s_add_u32 s72, s72, s62
    s_lshl_b32 s62, s57, 7
    s_add_u32 s72, s72, s62
    s_add_u32 s72, s72, 4194304
    v_mul_u32_u24 v8, 1056, v3
    v_add_u32 v239, 77056, v8
    s_lshl_b32 s61, s58, 2
    v_add_u32 v240, s61, v239
    v_lshl_add_u32 v8, v2, 4, v8
    s_mul_i32 s61, s58, 33792
    v_add_u32 v237, s61, v8
    v_add_u32 v238, 139264, v8
    s_lshl_b32 s61, s58, 10
    v_add_u32 v241, s61, v231
    v_mov_b32 v9, -1
    v_mov_b32 v8, 102416
    v_mov_b32 v220, s82
    v_mov_b32 v221, s82
    v_mov_b32 v222, s82
    v_mov_b32 v223, s82
    s_lshl_b32 s73, s56, 15
    s_lshl_b32 s62, s57, 8
    s_add_u32 s73, s73, s62
    s_add_u32 s73, s73, 1048576
    s_waitcnt lgkmcnt(0)
    s_add_u32 s4, s5, 0x9e3779b9
    v_mov_b32 v15, s4
    s_cmp_lg_u32 s3, 3
    s_cbranch_scc1 L_noann
    v_mov_b32 v14, s89
    s_lshr_b32 s63, s2, 3
    s_lshl_b32 s61, s55, 8
    s_lshl_b32 s62, s63, 3
    s_add_u32 s61, s61, s62
    s_add_u32 s61, s61, 1245184
    s_mov_b64 exec, 1
    buffer_store_dwordx2 v[14:15], v228, s[48:51], s61 offen sc1
    s_mov_b64 exec, -1
L_noann:
    v_mov_b32 v14, s4
    s_cmp_eq_u32 s56, 0
    s_cselect_b32 s87, 26, 20
L_sl1:
    buffer_load_dwordx4 v228, s[12:15], s84 offen lds
    s_add_u32 s84, s84, s85
    s_add_u32 m0, m0, 1056
    s_add_u32 s86, s86, 1
    s_cmp_lt_u32 s86, s87
    s_cbranch_scc1 L_sl1
    ds_write_b32 v8, v9
L_sl2:
    buffer_load_dwordx4 v228, s[12:15], s84 offen lds
    s_add_u32 s84, s84, s85
    s_add_u32 m0, m0, 1056
    s_add_u32 s86, s86, 1
    s_cmp_lt_u32 s86, 32
    s_cbranch_scc1 L_sl2
    v_and_b32 v6, 1, v2
    v_lshlrev_b32 v6, 3, v6
    v_lshrrev_b32 v6, v6, v15
    v_lshrrev_b32 v7, 1, v6
    v_lshrrev_b32 v10, 2, v6
    v_lshrrev_b32 v11, 3, v6
    v_lshrrev_b32 v224, 4, v6
    v_lshrrev_b32 v225, 5, v6
    v_lshrrev_b32 v226, 6, v6
    v_lshrrev_b32 v227, 7, v6
    s_waitcnt vmcnt(16)
    ds_read_b128 v[16:19], v237 offset:0
    ds_read_b128 v[20:23], v237 offset:64
    ds_read_b128 v[24:27], v237 offset:128
    ds_read_b128 v[28:31], v237 offset:192
    ds_read_b128 v[32:35], v237 offset:256
    ds_read_b128 v[36:39], v237 offset:320
    ds_read_b128 v[40:43], v237 offset:384
    ds_read_b128 v[44:47], v237 offset:448
    ds_read_b128 v[48:51], v237 offset:512
    ds_read_b128 v[52:55], v237 offset:576
    ds_read_b128 v[56:59], v237 offset:640
    ds_read_b128 v[60:63], v237 offset:704
    ds_read_b128 v[64:67], v237 offset:768
    ds_read_b128 v[68:71], v237 offset:832
    ds_read_b128 v[72:75], v237 offset:896
    ds_read_b128 v[76:79], v237 offset:960
    s_waitcnt vmcnt(0)
    ds_read_b128 v[144:147], v237 offset:16896
    ds_read_b128 v[148:151], v237 offset:16960
    ds_read_b128 v[152:155], v237 offset:17024
    ds_read_b128 v[156:159], v237 offset:17088
    ds_read_b128 v[160:163], v237 offset:17152
    ds_read_b128 v[164:167], v237 offset:17216
    ds_read_b128 v[168:171], v237 offset:17280
    ds_read_b128 v[172:175], v237 offset:17344
    ds_read_b128 v[176:179], v237 offset:17408
    ds_read_b128 v[180:183], v237 offset:17472
    ds_read_b128 v[184:187], v237 offset:17536
    ds_read_b128 v[188:191], v237 offset:17600
    ds_read_b128 v[192:195], v237 offset:17664
    ds_read_b128 v[196:199], v237 offset:17728
    ds_read_b128 v[200:203], v237 offset:17792
    ds_read_b128 v[204:207], v237 offset:17856
    s_mov_b32 s60, 0
    v_mov_b32 v251, 102400
Llw_38:
    ds_read_b128 v[244:247], v251
    s_waitcnt lgkmcnt(0)
    v_bitop3_b32 v244, v244, v245, v246 bitop3:0x80
    v_and_b32 v244, v244, v247
    v_cmp_ne_u32 vcc, -1, v244
    s_nop 0
    s_cmp_eq_u64 vcc, 0
    s_cbranch_scc1 Llok_39
    s_add_u32 s60, s60, 1
    s_cmp_lt_u32 s60, 1600000
    s_cbranch_scc1 Llw_38
Llok_39:
    ds_read_b128 v[80:83], v238 offset:0
    ds_read_b128 v[84:87], v238 offset:64
    ds_read_b128 v[88:91], v238 offset:128
    ds_read_b128 v[92:95], v238 offset:192
    ds_read_b128 v[96:99], v238 offset:256
    ds_read_b128 v[100:103], v238 offset:320
    ds_read_b128 v[104:107], v238 offset:384
    ds_read_b128 v[108:111], v238 offset:448
    ds_read_b128 v[112:115], v238 offset:512
    ds_read_b128 v[116:119], v238 offset:576
    ds_read_b128 v[120:123], v238 offset:640
    ds_read_b128 v[124:127], v238 offset:704
    ds_read_b128 v[128:131], v238 offset:768
    ds_read_b128 v[132:135], v238 offset:832
    ds_read_b128 v[136:139], v238 offset:896
    ds_read_b128 v[140:143], v238 offset:960
    s_waitcnt lgkmcnt(15)
    v_mfma_f32_16x16x32_bf16 v[208:211], v[16:19], v[80:83], 0
    v_mfma_f32_16x16x32_bf16 v[212:215], v[144:147], v[80:83], 0
    s_waitcnt lgkmcnt(14)
    v_mfma_f32_16x16x32_bf16 v[208:211], v[20:23], v[84:87], v[208:211]
    v_mfma_f32_16x16x32_bf16 v[212:215], v[148:151], v[84:87], v[212:215]
    s_waitcnt lgkmcnt(13)
    v_mfma_f32_16x16x32_bf16 v[208:211], v[24:27], v[88:91], v[208:211]
    v_mfma_f32_16x16x32_bf16 v[212:215], v[152:155], v[88:91], v[212:215]
    s_waitcnt lgkmcnt(12)
    v_mfma_f32_16x16x32_bf16 v[208:211], v[28:31], v[92:95], v[208:211]
    v_mfma_f32_16x16x32_bf16 v[212:215], v[156:159], v[92:95], v[212:215]
    s_waitcnt lgkmcnt(11)
    v_mfma_f32_16x16x32_bf16 v[208:211], v[32:35], v[96:99], v[208:211]
    v_mfma_f32_16x16x32_bf16 v[212:215], v[160:163], v[96:99], v[212:215]
    s_waitcnt lgkmcnt(10)
    v_mfma_f32_16x16x32_bf16 v[208:211], v[36:39], v[100:103], v[208:211]
    v_mfma_f32_16x16x32_bf16 v[212:215], v[164:167], v[100:103], v[212:215]
    s_waitcnt lgkmcnt(9)
    v_mfma_f32_16x16x32_bf16 v[208:211], v[40:43], v[104:107], v[208:211]
    v_mfma_f32_16x16x32_bf16 v[212:215], v[168:171], v[104:107], v[212:215]
    s_waitcnt lgkmcnt(8)
    v_mfma_f32_16x16x32_bf16 v[208:211], v[44:47], v[108:111], v[208:211]
    v_mfma_f32_16x16x32_bf16 v[212:215], v[172:175], v[108:111], v[212:215]
    s_waitcnt lgkmcnt(7)
    v_mfma_f32_16x16x32_bf16 v[208:211], v[48:51], v[112:115], v[208:211]
    v_mfma_f32_16x16x32_bf16 v[212:215], v[176:179], v[112:115], v[212:215]
    s_waitcnt lgkmcnt(6)
    v_mfma_f32_16x16x32_bf16 v[208:211], v[52:55], v[116:119], v[208:211]
    v_mfma_f32_16x16x32_bf16 v[212:215], v[180:183], v[116:119], v[212:215]
    s_waitcnt lgkmcnt(5)
    v_mfma_f32_16x16x32_bf16 v[208:211], v[56:59], v[120:123], v[208:211]
    v_mfma_f32_16x16x32_bf16 v[212:215], v[184:187], v[120:123], v[212:215]
    s_waitcnt lgkmcnt(4)
    v_mfma_f32_16x16x32_bf16 v[208:211], v[60:63], v[124:127], v[208:211]
    v_mfma_f32_16x16x32_bf16 v[212:215], v[188:191], v[124:127], v[212:215]
    s_waitcnt lgkmcnt(3)
    v_mfma_f32_16x16x32_bf16 v[208:211], v[64:67], v[128:131], v[208:211]
    v_mfma_f32_16x16x32_bf16 v[212:215], v[192:195], v[128:131], v[212:215]
    s_waitcnt lgkmcnt(2)
    v_mfma_f32_16x16x32_bf16 v[208:211], v[68:71], v[132:135], v[208:211]
    v_mfma_f32_16x16x32_bf16 v[212:215], v[196:199], v[132:135], v[212:215]
    s_waitcnt lgkmcnt(1)
    v_mfma_f32_16x16x32_bf16 v[208:211], v[72:75], v[136:139], v[208:211]
    v_mfma_f32_16x16x32_bf16 v[212:215], v[200:203], v[136:139], v[212:215]
    s_waitcnt lgkmcnt(0)
    v_mfma_f32_16x16x32_bf16 v[208:211], v[76:79], v[140:143], v[208:211]
    v_mfma_f32_16x16x32_bf16 v[212:215], v[204:207], v[140:143], v[212:215]
    s_nop 6
    v_max3_f32 v12, v208, v209, v210
    v_max_f32 v12, v12, v211
    v_max3_f32 v12, v12, v212, v213
    v_max3_f32 v12, v12, v214, v215
    v_mov_b32 v13, v12
    s_nop 1
    v_permlane16_swap_b32 v12, v13
    v_max_f32 v12, v12, v13
    v_mov_b32 v13, v12
    s_nop 1
    v_permlane32_swap_b32 v12, v13
    v_max_f32 v12, v12, v13
    ds_write_b32 v240, v12
    s_waitcnt lgkmcnt(0)
    s_barrier
    ds_read_b128 v[244:247], v239
    ds_read_b64_tr_b16 v[16:17], v229 offset:0
    ds_read_b64_tr_b16 v[18:19], v229 offset:16896
    ds_read_b64_tr_b16 v[20:21], v229 offset:32
    ds_read_b64_tr_b16 v[22:23], v229 offset:16928
    ds_read_b64_tr_b16 v[24:25], v229 offset:64
    ds_read_b64_tr_b16 v[26:27], v229 offset:16960
    ds_read_b64_tr_b16 v[28:29], v229 offset:96
    ds_read_b64_tr_b16 v[30:31], v229 offset:16992
    s_waitcnt lgkmcnt(8)
    v_max3_f32 v12, v244, v245, v246
    v_max_f32 v12, v12, v247
    v_sub_f32 v208, v208, v12
    v_sub_f32 v209, v209, v12
    v_sub_f32 v210, v210, v12
    v_sub_f32 v211, v211, v12
    v_sub_f32 v212, v212, v12
    v_sub_f32 v213, v213, v12
    v_sub_f32 v214, v214, v12
    v_sub_f32 v215, v215, v12
    v_exp_f32 v208, v208
    v_exp_f32 v209, v209
    v_exp_f32 v210, v210
    v_exp_f32 v211, v211
    v_exp_f32 v212, v212
    v_exp_f32 v213, v213
    v_exp_f32 v214, v214
    v_exp_f32 v215, v215
    v_cvt_pk_bf16_f32 v244, v208, v209
    v_cvt_pk_bf16_f32 v245, v210, v211
    v_cvt_pk_bf16_f32 v246, v212, v213
    v_cvt_pk_bf16_f32 v247, v214, v215
    ds_write_b128 v241, v[244:247]
    s_waitcnt lgkmcnt(0)
    s_barrier
    ds_read_b128 v[80:83], v231 offset:0
    ds_read_b128 v[84:87], v231 offset:1024
    ds_read_b128 v[88:91], v231 offset:2048
    ds_read_b128 v[92:95], v231 offset:3072
    ds_read_b64_tr_b16 v[32:33], v229 offset:33792
    ds_read_b64_tr_b16 v[34:35], v229 offset:50688
    ds_read_b64_tr_b16 v[36:37], v229 offset:33824
    ds_read_b64_tr_b16 v[38:39], v229 offset:50720
    ds_read_b64_tr_b16 v[40:41], v229 offset:33856
    ds_read_b64_tr_b16 v[42:43], v229 offset:50752
    ds_read_b64_tr_b16 v[44:45], v229 offset:33888
    ds_read_b64_tr_b16 v[46:47], v229 offset:50784
    s_cmp_lg_u32 s3, 0
    s_waitcnt lgkmcnt(11)
    v_mfma_f32_16x16x32_bf16 v[96:99], v[16:19], v[80:83], 0
    v_mfma_f32_16x16x32_bf16 v[100:103], v[20:23], v[80:83], 0
    v_mfma_f32_16x16x32_bf16 v[104:107], v[24:27], v[80:83], 0
    v_mfma_f32_16x16x32_bf16 v[108:111], v[28:31], v[80:83], 0
    s_waitcnt lgkmcnt(7)
    ds_read_b64_tr_b16 v[48:49], v230 offset:0
    ds_read_b64_tr_b16 v[50:51], v230 offset:16896
    ds_read_b64_tr_b16 v[52:53], v230 offset:32
    ds_read_b64_tr_b16 v[54:55], v230 offset:16928
    ds_read_b64_tr_b16 v[56:57], v230 offset:64
    ds_read_b64_tr_b16 v[58:59], v230 offset:16960
    ds_read_b64_tr_b16 v[60:61], v230 offset:96
    ds_read_b64_tr_b16 v[62:63], v230 offset:16992
    s_cbranch_scc1 L_nol
    v_mfma_f32_16x16x32_bf16 v[216:219], v[220:223], v[80:83], 0
    v_mfma_f32_16x16x32_bf16 v[216:219], v[220:223], v[84:87], v[216:219]
    v_mfma_f32_16x16x32_bf16 v[216:219], v[220:223], v[88:91], v[216:219]
    v_mfma_f32_16x16x32_bf16 v[216:219], v[220:223], v[92:95], v[216:219]
L_nol:
    s_waitcnt lgkmcnt(8)
    v_mfma_f32_16x16x32_bf16 v[96:99], v[32:35], v[84:87], v[96:99]
    v_mfma_f32_16x16x32_bf16 v[100:103], v[36:39], v[84:87], v[100:103]
    v_mfma_f32_16x16x32_bf16 v[104:107], v[40:43], v[84:87], v[104:107]
    v_mfma_f32_16x16x32_bf16 v[108:111], v[44:47], v[84:87], v[108:111]
    ds_read_b64_tr_b16 v[64:65], v230 offset:33792
    ds_read_b64_tr_b16 v[66:67], v230 offset:50688
    ds_read_b64_tr_b16 v[68:69], v230 offset:33824
    ds_read_b64_tr_b16 v[70:71], v230 offset:50720
    ds_read_b64_tr_b16 v[72:73], v230 offset:33856
    ds_read_b64_tr_b16 v[74:75], v230 offset:50752
    ds_read_b64_tr_b16 v[76:77], v230 offset:33888
    ds_read_b64_tr_b16 v[78:79], v230 offset:50784
    s_waitcnt lgkmcnt(8)
    v_mfma_f32_16x16x32_bf16 v[96:99], v[48:51], v[88:91], v[96:99]
    v_mfma_f32_16x16x32_bf16 v[100:103], v[52:55], v[88:91], v[100:103]
    v_mfma_f32_16x16x32_bf16 v[104:107], v[56:59], v[88:91], v[104:107]
    v_mfma_f32_16x16x32_bf16 v[108:111], v[60:63], v[88:91], v[108:111]
    s_waitcnt lgkmcnt(0)
    v_mfma_f32_16x16x32_bf16 v[96:99], v[64:67], v[92:95], v[96:99]
    v_mfma_f32_16x16x32_bf16 v[100:103], v[68:71], v[92:95], v[100:103]
    v_mfma_f32_16x16x32_bf16 v[104:107], v[72:75], v[92:95], v[104:107]
    v_mfma_f32_16x16x32_bf16 v[108:111], v[76:79], v[92:95], v[108:111]
    s_cbranch_scc1 L_pvout
    v_mov_b32 v13, v216
    s_mov_b64 exec, 0xffff
    buffer_store_dwordx4 v[12:15], v228, s[48:51], s73 offen sc1
    s_mov_b64 exec, -1
    s_branch L_pvout
L_exit:
    s_endpgm
.section .rodata,"a"
.p2align 6
.amdhsa_kernel sequential_preLN__compressed_kv_cla__glu_gated_reglu__decode_kernel
  .amdhsa_next_free_vgpr 256
  .amdhsa_next_free_sgpr 102
  .amdhsa_accum_offset 256
  .amdhsa_group_segment_fixed_size 0
  .amdhsa_kernarg_size 104
  .amdhsa_user_sgpr_count 2
  .amdhsa_user_sgpr_kernarg_segment_ptr 1
  .amdhsa_system_sgpr_workgroup_id_x 1
.end_amdhsa_kernel
```
